```python
import torch

def _softmax(x, axis=-1):
    return torch.softmax(x, dim=axis)
def _gelu(x):
    return torch.nn.functional.gelu(x, approximate="tanh")
def _silu(x):
    return torch.nn.functional.silu(x)
def _sigmoid(x):
    return torch.sigmoid(x)
def _layernorm(x, axis=-1, eps=1e-5):
    m = x.mean(dim=axis, keepdim=True)
    v = x.var(dim=axis, keepdim=True, unbiased=False)
    return (x - m) / torch.sqrt(v + eps)
def _scatter_add(tgt, idx, src, axis=0):
    return tgt.clone().index_add_(axis, idx, src)
def _segment_sum(src, seg, n):
    out = torch.zeros((n,) + src.shape[1:], dtype=src.dtype)
    return out.index_add_(0, seg, src)
def _pad(x, pw):
    flat = tuple(v for pair in reversed(pw) for v in pair)
    return torch.nn.functional.pad(x, flat)

kernel_name = 'sequential_preLN__ssm_conv_s4d__dense_activation_gelu__prompt'

def setup_inputs():

    _w = (lambda a: (lambda t: t.to(torch.bfloat16) if t.is_floating_point() else t)(torch.as_tensor(a)))
    def _A_setup():
        Bsz, L, D, N = 1, 2048, 512, 128
        return {
            "u": _w((lambda *s: torch.randn(*s, dtype=torch.bfloat16) * 0.05)(Bsz, L, D)),
            "log_A_real": _w((lambda *s: torch.randn(*s, dtype=torch.bfloat16) * 6.4)(D, N) * 0.5),
            "A_imag": _w((lambda *s: torch.randn(*s, dtype=torch.bfloat16) * 0.05)(D, N) * 3.14),
            "C_real": _w((lambda *s: torch.randn(*s, dtype=torch.bfloat16) * 0.05)(D, N) / N ** 0.5),
            "C_imag": _w((lambda *s: torch.randn(*s, dtype=torch.bfloat16) * 0.05)(D, N) / N ** 0.5),
            "log_dt": _w((lambda *s: torch.randn(*s, dtype=torch.bfloat16) * 0.05)(D) * 0.5 - 4.0),
            "D_skip": _w((lambda *s: torch.randn(*s, dtype=torch.bfloat16) * 0.05)(D)),
        }
    _A_in = _A_setup()

    def _B_setup():
        B, S, D, F = 1, 2048, 512, 1792
        return {
            "x": _w((lambda *s: torch.randn(*s, dtype=torch.bfloat16) * 0.05)(B, S, D)),
            "w1": _w((lambda *s: torch.randn(*s, dtype=torch.bfloat16) * 0.8)(D, F) * (D ** -0.5)),
            "b1": _w((lambda *s: torch.randn(*s, dtype=torch.bfloat16) * 12.8)(F) * 0.01),
            "w2": _w((lambda *s: torch.randn(*s, dtype=torch.bfloat16) * 0.4)(F, D) * (F ** -0.5)),
            "b2": _w((lambda *s: torch.randn(*s, dtype=torch.bfloat16) * 6.4)(D) * 0.01),
        }
    _B_in = _B_setup()

    return {
        "A_u": _A_in["u"],
        "A_log_A_real": _A_in["log_A_real"],
        "A_A_imag": _A_in["A_imag"],
        "A_C_real": _A_in["C_real"],
        "A_C_imag": _A_in["C_imag"],
        "A_log_dt": _A_in["log_dt"],
        "A_D_skip": _A_in["D_skip"],
        "B_x": _B_in["x"],
        "B_w1": _B_in["w1"],
        "B_b1": _B_in["b1"],
        "B_w2": _B_in["w2"],
        "B_b2": _B_in["b2"],
    }

def reference(A_u, A_log_A_real, A_A_imag, A_C_real, A_C_imag, A_log_dt, A_D_skip, B_x, B_w1, B_b1, B_w2, B_b2):
    def _A_ref(u, log_A_real, A_imag, C_real, C_imag, log_dt, D_skip):
        L = u.shape[1]
        dt = torch.exp(log_dt)
        A = -torch.exp(log_A_real) + 1j * A_imag
        C = (C_real + 1j * C_imag) * dt[:, None]
        pos = (lambda x, dt: x.to(dt))(torch.arange(L), log_dt.dtype)
        P = torch.exp((A * dt[:, None])[:, :, None] * pos[None, None, :])
        K = 2.0 * torch.einsum("dn,dnl->dl", C, P).real
        L2 = 2 * L
        u_t = (lambda x, *d: x.permute(*d))(u, 0, 2, 1)
        Kf = (lambda x, *a, **k: torch.fft.rfft(x.float(), *a, **k))(K, L2)
        Uf = (lambda x, *a, **k: torch.fft.rfft(x.float(), *a, **k))(u_t, L2)
        y = (lambda x, *a, **k: torch.fft.irfft(x, *a, **k).to(torch.bfloat16))(Uf * Kf[None, :, :], L2)[:, :, :L]
        y = (lambda x, *d: x.permute(*d))(y, 0, 2, 1)
        return y + u * D_skip[None, None, :]

    def _B_ref(x, w1, b1, w2, b2):
        h = torch.einsum("bsd,df->bsf", x, w1) + b1
        h = _gelu(h)
        return torch.einsum("bsf,fd->bsd", h, w2) + b2

    x = A_u
    h = x + _A_ref(_layernorm(x, axis=-1), A_log_A_real, A_A_imag, A_C_real, A_C_imag, A_log_dt, A_D_skip)
    h2 = h + _B_ref(_layernorm(h, axis=-1), B_w1, B_b1, B_w2, B_b2)
    return h2
```

```asm
; @launch grid=(256,1,1) block=(256,1,1) lds=163840
.amdgcn_target "amdgcn-amd-amdhsa--gfx950"
.text
.globl sequential_preLN__ssm_conv_s4d__dense_activation_gelu__prompt_kernel
.p2align 8
.type sequential_preLN__ssm_conv_s4d__dense_activation_gelu__prompt_kernel,@function
sequential_preLN__ssm_conv_s4d__dense_activation_gelu__prompt_kernel:
    s_cmp_ge_u32 s2, 256
    s_cbranch_scc1 sequential_preLN__ssm_conv_s4d__dense_activation_gelu__prompt_kernel_exit1
    s_load_dwordx16 s[36:51], s[0:1], 0
    s_load_dwordx8 s[52:59], s[0:1], 64
    s_load_dwordx4 s[60:63], s[0:1], 96
    s_load_dwordx2 s[64:65], s[0:1], 112
    v_and_b32 v1, 63, v0
    v_lshrrev_b32 v6, 6, v0
    v_lshlrev_b32 v2, 4, v1
    s_getpc_b64 s[28:29]
sequential_preLN__ssm_conv_s4d__dense_activation_gelu__prompt_kernel_pc2:
    s_add_u32 s28, s28, sequential_preLN__ssm_conv_s4d__dense_activation_gelu__prompt_kernel_gtab-sequential_preLN__ssm_conv_s4d__dense_activation_gelu__prompt_kernel_pc2
    s_addc_u32 s29, s29, 0
    v_readfirstlane_b32 s20, v6
    v_lshlrev_b32 v11, 4, v0
    s_and_b32 s26, s2, 7
    s_lshr_b32 s27, s2, 3
    s_lshl_b32 s21, s26, 5
    s_add_u32 s21, s21, s27
    s_lshr_b32 s66, s27, 4
    s_lshl_b32 s72, s26, 1
    s_add_u32 s66, s66, s72
    s_and_b32 s67, s27, 15
    s_lshr_b32 s69, s27, 3
    s_lshl_b32 s72, s26, 2
    s_add_u32 s69, s69, s72
    s_and_b32 s70, s27, 7
    s_lshl_b32 s71, s21, 1
    s_lshr_b32 s22, s20, 1
    s_and_b32 s23, s20, 1
    s_lshr_b32 s72, s27, 4
    s_lshl_b32 s72, s72, 3
    s_add_u32 s72, s72, s26
    s_lshl_b32 s72, s72, 2
    s_and_b32 s27, s27, 15
    s_lshl_b32 s27, s27, 8
    s_add_u32 s27, s27, s72
    s_add_u32 s27, s27, 4194304
    v_lshlrev_b32 v3, 12, v1
    v_add_u32 v3, s27, v3
    s_and_b32 s27, s2, 7
    s_lshl_b32 s27, s27, 12
    s_add_u32 s27, s27, 4194304
    v_lshrrev_b32 v4, 2, v1
    v_lshlrev_b32 v4, 8, v4
    v_and_b32 v7, 3, v1
    v_lshl_add_u32 v4, v7, 4, v4
    v_add_u32 v4, s27, v4
    s_lshl_b32 s24, s2, 13
    s_lshl_b32 s25, s20, 11
    s_add_u32 s25, s25, s24
    s_add_u32 s26, s71, s22
    s_lshl_b32 s27, s26, 8
    s_lshl_b32 s30, s23, 7
    s_add_u32 s27, s27, s30
    v_lshlrev_b32 v12, 1, v1
    s_lshl_b32 s26, s26, 1
    v_mov_b32 v13, s26
    s_lshr_b32 s4, s2, 2
    s_and_b32 s5, s2, 3
    v_lshrrev_b32 v7, 4, v0
    v_and_b32 v8, 15, v0
    v_lshlrev_b32 v14, 10, v7
    v_lshl_add_u32 v14, v8, 4, v14
    s_and_b32 s31, s4, 3
    s_cmp_eq_u32 s31, 3
    s_cselect_b32 s6, 32, 1
    s_lshl_b32 s7, s31, 5
    s_add_u32 s7, s7, 16
    s_cmp_eq_u32 s31, 3
    s_cselect_b32 s7, 19, s7
    v_and_b32 v9, 3, v7
    v_mul_u32_u24 v15, s6, v9
    v_and_b32 v7, 12, v7
    v_add3_u32 v15, v15, v7, s7
    v_lshlrev_b32 v15, 10, v15
    v_lshl_add_u32 v15, v8, 4, v15
    v_mov_b32 v10, 0x10000000
    v_cmp_eq_u32 vcc, 3, v9
    s_nop 1
    v_cndmask_b32 v15, v15, v10, vcc
    s_waitcnt lgkmcnt(0)
    s_mov_b32 s8, s64
    s_mov_b32 s9, s65
    s_mov_b32 s10, 0x2000000
    s_mov_b32 s11, 0x00020000
    s_mov_b32 s51, 4263936
    s_load_dword s50, s[64:65], s51
    s_mov_b32 s12, s36
    s_mov_b32 s13, s37
    s_mov_b32 s14, 0x200000
    s_mov_b32 s15, 0x00020000
    buffer_load_dwordx4 v[16:19], v2, s[12:15], s25 offen nt
    buffer_load_dwordx4 v[20:23], v2, s[12:15], s25 offen offset:1024 nt
    s_cmp_eq_u32 s20, 1
    s_cbranch_scc0 sequential_preLN__ssm_conv_s4d__dense_activation_gelu__prompt_kernel_cp03
    s_lshr_b32 s31, s2, 3
    s_lshl_b32 s31, s31, 10
    v_add_u32 v28, s31, v2
    s_mov_b32 s31, sequential_preLN__ssm_conv_s4d__dense_activation_gelu__prompt_kernel_codeend-sequential_preLN__ssm_conv_s4d__dense_activation_gelu__prompt_kernel-16
    v_min_u32 v28, s31, v28
    s_sub_u32 s34, s28, sequential_preLN__ssm_conv_s4d__dense_activation_gelu__prompt_kernel_gtab-sequential_preLN__ssm_conv_s4d__dense_activation_gelu__prompt_kernel
    s_subb_u32 s35, s29, 0
    global_load_dwordx4 v[24:27], v28, s[34:35]
sequential_preLN__ssm_conv_s4d__dense_activation_gelu__prompt_kernel_cp03:
    v_add_u32 v12, s27, v12
    global_load_ushort v32, v13, s[46:47] nt
    global_load_ushort v28, v12, s[38:39] nt
    global_load_ushort v29, v12, s[40:41] nt
    global_load_ushort v30, v12, s[42:43] nt
    global_load_ushort v31, v12, s[44:45] nt
    s_lshr_b32 s30, s4, 2
    s_mul_i32 s33, s30, 114688
    s_lshl_b32 s30, s5, 8
    s_add_u32 s33, s33, s30
    s_and_b32 s30, s4, 3
    s_lshl_b32 s30, s30, 15
    s_add_u32 s32, s33, s30
    s_mov_b32 s44, s52
    s_mov_b32 s45, s53
    s_mov_b32 s46, 0x1c0000
    s_mov_b32 s47, 0x00020000
    s_mul_i32 s40, s2, 7168
    s_mul_i32 s41, s20, 1792
    s_add_u32 s40, s40, s41
    s_lshl_b32 s31, s21, 2
    s_load_dword s3, s[48:49], s31
    s_mul_i32 s26, s20, 4224
    s_add_u32 s26, s26, 0
    v_lshlrev_b32 v33, 5, v1
    v_add_u32 v33, s26, v33
    v_bfe_u32 v7, v1, 2, 2
    v_mul_u32_u24 v34, 2112, v7
    v_lshrrev_b32 v7, 4, v1
    v_lshlrev_b32 v7, 5, v7
    v_and_b32 v8, 3, v1
    v_lshlrev_b32 v8, 3, v8
    v_add3_u32 v34, v34, v7, v8
    s_lshl_b32 s26, s20, 9
    s_add_u32 s26, s26, 0
    v_add_u32 v34, s26, v34
    v_mov_b32 v48, 0
    v_mov_b32 v49, 0
    v_mov_b32 v50, 0
    v_mov_b32 v51, 0
    v_bfe_u32 v7, v0, 5, 1
    v_mul_u32_u24 v35, 17088, v7
    v_and_b32 v7, 31, v0
    v_lshl_add_u32 v35, v7, 4, v35
    v_add_u32 v35, 114688, v35
    v_cmp_gt_u32 vcc, 64, v0
    s_nop 2
    s_and_saveexec_b64 s[34:35], vcc
    s_cbranch_execz sequential_preLN__ssm_conv_s4d__dense_activation_gelu__prompt_kernel_z14
    ds_write_b128 v35, v[48:51] offset:0
sequential_preLN__ssm_conv_s4d__dense_activation_gelu__prompt_kernel_z14:
    s_mov_b64 exec, s[34:35]
    v_bfe_u32 v7, v0, 2, 1
    v_mul_u32_u24 v35, 17088, v7
    v_bfe_u32 v7, v0, 1, 1
    v_mul_u32_u24 v7, 4160, v7
    v_and_b32 v8, 1, v0
    v_lshlrev_b32 v8, 4, v8
    v_add3_u32 v35, v35, v7, v8
    v_add_u32 v35, 114688, v35
    v_lshrrev_b32 v7, 3, v0
    v_cmp_eq_u32 vcc, 8, v7
    s_nop 2
    s_and_saveexec_b64 s[34:35], vcc
    s_cbranch_execz sequential_preLN__ssm_conv_s4d__dense_activation_gelu__prompt_kernel_z25
    ds_write_b128 v35, v[48:51] offset:12800
sequential_preLN__ssm_conv_s4d__dense_activation_gelu__prompt_kernel_z25:
    s_mov_b64 exec, s[34:35]
    v_lshrrev_b32 v7, 4, v0
    v_and_b32 v8, 15, v0
    v_mul_u32_u24 v52, 288, v7
    v_lshl_add_u32 v52, v8, 4, v52
    v_add_u32 v52, 81920, v52
    v_lshrrev_b32 v7, 2, v1
    v_mul_u32_u24 v53, 288, v7
    v_and_b32 v8, 3, v1
    v_lshl_add_u32 v53, v8, 3, v53
    s_lshl_b32 s26, s20, 6
    s_add_u32 s26, s26, 81920
    v_add_u32 v53, s26, v53
    s_mov_b32 s30, 0xffff0000
    v_mov_b32 v72, 0x3b000000
    s_waitcnt vmcnt(5)
    s_mov_b32 s12, s56
    s_mov_b32 s13, s57
    s_mov_b32 s14, 0x1c0000
    s_mov_b32 s15, 0x00020000
    buffer_load_dwordx4 v[36:39], v14, s[12:15], s32 offen nt
    buffer_load_dwordx4 v[40:43], v15, s[12:15], s33 offen nt
    v_lshlrev_b32 v54, 16, v16
    v_and_b32 v55, s30, v16
    v_lshlrev_b32 v56, 16, v17
    v_and_b32 v57, s30, v17
    buffer_load_dwordx4 v[44:47], v2, s[44:47], s40 offen offset:0
    v_lshlrev_b32 v58, 16, v18
    v_and_b32 v59, s30, v18
    v_lshlrev_b32 v60, 16, v19
    v_and_b32 v61, s30, v19
    buffer_load_dwordx4 v[44:47], v2, s[44:47], s40 offen offset:768
    v_lshlrev_b32 v62, 16, v20
    v_and_b32 v63, s30, v20
    v_lshlrev_b32 v64, 16, v21
    v_and_b32 v65, s30, v21
    v_lshlrev_b32 v66, 16, v22
    v_and_b32 v67, s30, v22
    v_lshlrev_b32 v68, 16, v23
    v_and_b32 v69, s30, v23
    v_readfirstlane_b32 s34, v54
    v_readfirstlane_b32 s35, v62
    s_nop 0
    v_mov_b32 v82, s34
    v_mov_b32 v84, s35
    v_pk_add_f32 v[86:87], v[54:55], v[82:83] op_sel_hi:[1,0] neg_lo:[0,1] neg_hi:[0,1]
    v_pk_add_f32 v[88:89], v[56:57], v[82:83] op_sel_hi:[1,0] neg_lo:[0,1] neg_hi:[0,1]
    v_pk_add_f32 v[90:91], v[58:59], v[82:83] op_sel_hi:[1,0] neg_lo:[0,1] neg_hi:[0,1]
    v_pk_add_f32 v[92:93], v[60:61], v[82:83] op_sel_hi:[1,0] neg_lo:[0,1] neg_hi:[0,1]
    v_pk_add_f32 v[94:95], v[62:63], v[84:85] op_sel_hi:[1,0] neg_lo:[0,1] neg_hi:[0,1]
    v_pk_add_f32 v[96:97], v[64:65], v[84:85] op_sel_hi:[1,0] neg_lo:[0,1] neg_hi:[0,1]
    v_pk_add_f32 v[98:99], v[66:67], v[84:85] op_sel_hi:[1,0] neg_lo:[0,1] neg_hi:[0,1]
    v_pk_add_f32 v[100:101], v[68:69], v[84:85] op_sel_hi:[1,0] neg_lo:[0,1] neg_hi:[0,1]
    v_pk_add_f32 v[74:75], v[86:87], v[88:89]
    v_pk_add_f32 v[76:77], v[90:91], v[92:93]
    v_pk_add_f32 v[78:79], v[94:95], v[96:97]
    v_pk_add_f32 v[80:81], v[98:99], v[100:101]
    v_pk_mul_f32 v[102:103], v[86:87], v[86:87]
    v_pk_mul_f32 v[104:105], v[94:95], v[94:95]
    v_pk_add_f32 v[74:75], v[74:75], v[76:77]
    v_pk_add_f32 v[78:79], v[78:79], v[80:81]
    v_pk_fma_f32 v[102:103], v[88:89], v[88:89], v[102:103]
    v_pk_fma_f32 v[104:105], v[96:97], v[96:97], v[104:105]
    v_pk_fma_f32 v[102:103], v[90:91], v[90:91], v[102:103]
    v_pk_fma_f32 v[104:105], v[98:99], v[98:99], v[104:105]
    v_pk_fma_f32 v[102:103], v[92:93], v[92:93], v[102:103]
    v_pk_fma_f32 v[104:105], v[100:101], v[100:101], v[104:105]
    v_add_f32 v70, v74, v75
    v_add_f32 v71, v78, v79
    v_add_f32 v102, v102, v103
    v_add_f32 v104, v104, v105
    v_add_f32_dpp v70, v70, v70 row_ror:8 row_mask:0xf bank_mask:0xf
    v_add_f32_dpp v102, v102, v102 row_ror:8 row_mask:0xf bank_mask:0xf
    v_add_f32_dpp v71, v71, v71 row_ror:8 row_mask:0xf bank_mask:0xf
    v_add_f32_dpp v104, v104, v104 row_ror:8 row_mask:0xf bank_mask:0xf
    v_add_f32_dpp v70, v70, v70 row_ror:4 row_mask:0xf bank_mask:0xf
    v_add_f32_dpp v102, v102, v102 row_ror:4 row_mask:0xf bank_mask:0xf
    v_add_f32_dpp v71, v71, v71 row_ror:4 row_mask:0xf bank_mask:0xf
    v_add_f32_dpp v104, v104, v104 row_ror:4 row_mask:0xf bank_mask:0xf
    v_add_f32_dpp v70, v70, v70 row_ror:2 row_mask:0xf bank_mask:0xf
    v_add_f32_dpp v102, v102, v102 row_ror:2 row_mask:0xf bank_mask:0xf
    v_add_f32_dpp v71, v71, v71 row_ror:2 row_mask:0xf bank_mask:0xf
    v_add_f32_dpp v104, v104, v104 row_ror:2 row_mask:0xf bank_mask:0xf
    v_add_f32_dpp v70, v70, v70 row_ror:1 row_mask:0xf bank_mask:0xf
    v_add_f32_dpp v102, v102, v102 row_ror:1 row_mask:0xf bank_mask:0xf
    v_add_f32_dpp v71, v71, v71 row_ror:1 row_mask:0xf bank_mask:0xf
    v_add_f32_dpp v104, v104, v104 row_ror:1 row_mask:0xf bank_mask:0xf
    v_add_f32_dpp v70, v70, v70 row_bcast:15 row_mask:0xa bank_mask:0xf
    v_add_f32_dpp v102, v102, v102 row_bcast:15 row_mask:0xa bank_mask:0xf
    v_add_f32_dpp v71, v71, v71 row_bcast:15 row_mask:0xa bank_mask:0xf
    v_add_f32_dpp v104, v104, v104 row_bcast:15 row_mask:0xa bank_mask:0xf
    v_add_f32_dpp v70, v70, v70 row_bcast:31 row_mask:0xc bank_mask:0xf
    v_add_f32_dpp v102, v102, v102 row_bcast:31 row_mask:0xc bank_mask:0xf
    v_add_f32_dpp v71, v71, v71 row_bcast:31 row_mask:0xc bank_mask:0xf
    v_add_f32_dpp v104, v104, v104 row_bcast:31 row_mask:0xc bank_mask:0xf
    v_readlane_b32 s26, v70, 63
    v_readlane_b32 s27, v102, 63
    v_readlane_b32 s6, v71, 63
    v_readlane_b32 s7, v104, 63
    s_mov_b32 s31, 0x3b000000
    v_mul_f32 v73, s26, v72
    v_mul_f32 v111, s27, v72
    v_mul_f32 v110, s6, v72
    v_mul_f32 v112, s7, v72
    v_add_f32 v106, v82, v73
    v_fma_f32 v111, -v73, v73, v111
    v_add_f32 v108, v84, v110
    v_fma_f32 v112, -v110, v110, v112
    v_max_f32 v111, 0, v111
    v_max_f32 v112, 0, v112
    s_mov_b32 s25, 0x3727c5ac
    v_cvt_pk_bf16_f32 v114, v111, v111
    v_and_b32 v114, s30, v114
    v_cvt_pk_bf16_f32 v116, v112, v112
    v_and_b32 v116, s30, v116
    v_add_f32 v114, s25, v114
    v_add_f32 v116, s25, v116
    v_cvt_pk_bf16_f32 v114, v114, v114
    v_and_b32 v114, s30, v114
    v_cvt_pk_bf16_f32 v116, v116, v116
    v_and_b32 v116, s30, v116
    v_sqrt_f32 v114, v114
    v_sqrt_f32 v116, v116
    v_cvt_pk_bf16_f32 v106, v106, v106
    v_and_b32 v106, s30, v106
    v_cvt_pk_bf16_f32 v108, v108, v108
    v_and_b32 v108, s30, v108
    v_cvt_pk_bf16_f32 v114, v114, v114
    v_and_b32 v114, s30, v114
    v_cvt_pk_bf16_f32 v116, v116, v116
    v_and_b32 v116, s30, v116
    v_rcp_f32 v114, v114
    v_rcp_f32 v116, v116
    v_pk_add_f32 v[54:55], v[54:55], v[106:107] op_sel_hi:[1,0] neg_lo:[0,1] neg_hi:[0,1]
    v_pk_add_f32 v[56:57], v[56:57], v[106:107] op_sel_hi:[1,0] neg_lo:[0,1] neg_hi:[0,1]
    v_pk_add_f32 v[58:59], v[58:59], v[106:107] op_sel_hi:[1,0] neg_lo:[0,1] neg_hi:[0,1]
    v_pk_add_f32 v[60:61], v[60:61], v[106:107] op_sel_hi:[1,0] neg_lo:[0,1] neg_hi:[0,1]
    v_pk_add_f32 v[62:63], v[62:63], v[108:109] op_sel_hi:[1,0] neg_lo:[0,1] neg_hi:[0,1]
    v_pk_add_f32 v[64:65], v[64:65], v[108:109] op_sel_hi:[1,0] neg_lo:[0,1] neg_hi:[0,1]
    v_pk_add_f32 v[66:67], v[66:67], v[108:109] op_sel_hi:[1,0] neg_lo:[0,1] neg_hi:[0,1]
    v_pk_add_f32 v[68:69], v[68:69], v[108:109] op_sel_hi:[1,0] neg_lo:[0,1] neg_hi:[0,1]
    v_pk_mul_f32 v[54:55], v[54:55], v[114:115] op_sel_hi:[1,0]
    v_pk_mul_f32 v[56:57], v[56:57], v[114:115] op_sel_hi:[1,0]
    v_pk_mul_f32 v[58:59], v[58:59], v[114:115] op_sel_hi:[1,0]
    v_pk_mul_f32 v[60:61], v[60:61], v[114:115] op_sel_hi:[1,0]
    v_pk_mul_f32 v[62:63], v[62:63], v[116:117] op_sel_hi:[1,0]
    v_pk_mul_f32 v[64:65], v[64:65], v[116:117] op_sel_hi:[1,0]
    v_pk_mul_f32 v[66:67], v[66:67], v[116:117] op_sel_hi:[1,0]
    v_pk_mul_f32 v[68:69], v[68:69], v[116:117] op_sel_hi:[1,0]
    v_cvt_pk_bf16_f32 v120, v54, v55
    v_cvt_pk_bf16_f32 v121, v56, v57
    v_cvt_pk_bf16_f32 v122, v58, v59
    v_cvt_pk_bf16_f32 v123, v60, v61
    v_cvt_pk_bf16_f32 v124, v62, v63
    v_cvt_pk_bf16_f32 v125, v64, v65
    v_cvt_pk_bf16_f32 v126, v66, v67
    v_cvt_pk_bf16_f32 v127, v68, v69
    s_mov_b32 s26, 0x05040100
    s_mov_b32 s27, 0x07060302
    v_perm_b32 v128, v120, v16, s26
    v_perm_b32 v129, v120, v16, s27
    v_perm_b32 v130, v121, v17, s26
    v_perm_b32 v131, v121, v17, s27
    v_perm_b32 v132, v122, v18, s26
    v_perm_b32 v133, v122, v18, s27
    v_perm_b32 v134, v123, v19, s26
    v_perm_b32 v135, v123, v19, s27
    ds_write_b128 v33, v[128:131] offset:0
    ds_write_b128 v33, v[132:135] offset:16
    v_perm_b32 v136, v124, v20, s26
    v_perm_b32 v137, v124, v20, s27
    v_perm_b32 v138, v125, v21, s26
    v_perm_b32 v139, v125, v21, s27
    v_perm_b32 v140, v126, v22, s26
    v_perm_b32 v141, v126, v22, s27
    v_perm_b32 v142, v127, v23, s26
    v_perm_b32 v143, v127, v23, s27
    ds_write_b128 v33, v[136:139] offset:2112
    ds_write_b128 v33, v[140:143] offset:2128
    s_waitcnt lgkmcnt(0)
    s_barrier
    ds_read_b64_tr_b16 v[144:145], v34 offset:0
    ds_read_b64_tr_b16 v[146:147], v34 offset:8448
    ds_read_b64_tr_b16 v[148:149], v34 offset:128
    ds_read_b64_tr_b16 v[150:151], v34 offset:8576
    ds_read_b64_tr_b16 v[152:153], v34 offset:256
    ds_read_b64_tr_b16 v[154:155], v34 offset:8704
    ds_read_b64_tr_b16 v[156:157], v34 offset:384
    ds_read_b64_tr_b16 v[158:159], v34 offset:8832
    s_lshl_b32 s26, s24, 1
    s_lshl_b32 s27, s20, 12
    s_add_u32 s26, s26, s27
    s_add_u32 s26, s26, 0
    s_add_u32 s51, s50, 0x9e37
    s_and_b32 s51, s51, 0xffff
    s_lshr_b32 s50, s50, 16
    s_add_u32 s50, s50, 0x357
    s_and_b32 s50, s50, 0x8fff
    s_or_b32 s50, s50, 0x1000
    s_lshl_b32 s50, s50, 16
    s_or_b32 s51, s51, s50
    s_waitcnt lgkmcnt(6)
    buffer_store_dwordx4 v[144:147], v2, s[8:11], s26 offen offset:0 sc1
    s_waitcnt lgkmcnt(4)
    buffer_store_dwordx4 v[148:151], v2, s[8:11], s26 offen offset:1024 sc1
    s_waitcnt lgkmcnt(2)
    buffer_store_dwordx4 v[152:155], v2, s[8:11], s26 offen offset:2048 sc1
    s_waitcnt lgkmcnt(0)
    buffer_store_dwordx4 v[156:159], v2, s[8:11], s26 offen offset:3072 sc1
    global_load_dwordx4 v[160:163], v11, s[28:29]
    global_load_ushort v113, v11, s[28:29] offset:16
    s_barrier
    s_mov_b32 s30, 0xffff0000
    s_waitcnt vmcnt(10)
    s_mov_b32 s24, 0x3fb8aa3b
    s_mov_b32 s25, 0x32a57060
    s_mov_b32 s26, 0x3f317218
    s_mov_b32 s27, 0x3e22f983
    v_lshlrev_b32 v32, 16, v32
    v_lshlrev_b32 v28, 16, v28
    v_lshlrev_b32 v29, 16, v29
    v_lshlrev_b32 v30, 16, v30
    v_lshlrev_b32 v31, 16, v31
    v_mul_f32 v7, s24, v32
    v_mul_f32 v10, s24, v28
    v_fma_f32 v8, v32, s24, -v7
    v_fma_f32 v12, v28, s24, -v10
    v_fmac_f32 v8, s25, v32
    v_fmac_f32 v12, s25, v28
    v_exp_f32 v7, v7
    v_exp_f32 v10, v10
    v_mul_f32 v8, s26, v8
    v_mul_f32 v12, s26, v12
    v_fma_f32 v7, v7, v8, v7
    v_fma_f32 v10, v10, v12, v10
    v_cvt_pk_bf16_f32 v32, v7, v10
    v_and_b32 v28, s30, v32
    v_lshlrev_b32 v32, 16, v32
    v_mul_f32 v28, v28, v32
    v_mul_f32 v29, v29, v32
    v_mul_f32 v30, v30, v32
    v_mul_f32 v31, v31, v32
    v_mul_f32 v28, s24, v28
    v_mul_f32 v29, s27, v29
    s_mov_b32 s24, 0xc2800000
    s_mov_b32 s25, 0x42800000
    v_mul_f32 v7, s24, v28
    v_mul_f32 v8, s25, v29
    v_exp_f32 v7, v7
    v_fract_f32 v8, v8
    v_cos_f32 v14, v8
    v_sin_f32 v15, v8
    v_mul_f32 v14, v14, v7
    v_mul_f32 v15, v15, v7
    v_sub_f32 v16, 0, v15
    v_mov_b32 v17, v14
    s_mov_b32 s24, 0xbf800000
    s_mov_b32 s25, 0x3f800000
    v_mul_f32 v7, s24, v28
    v_mul_f32 v8, s25, v29
    v_exp_f32 v7, v7
    v_fract_f32 v8, v8
    v_cos_f32 v18, v8
    v_sin_f32 v19, v8
    v_mul_f32 v18, v18, v7
    v_mul_f32 v19, v19, v7
    v_sub_f32 v20, 0, v19
    v_mov_b32 v21, v18
    s_mov_b32 s24, 0xc0000000
    s_mov_b32 s25, 0x40000000
    v_mul_f32 v7, s24, v28
    v_mul_f32 v8, s25, v29
    v_exp_f32 v7, v7
    v_fract_f32 v8, v8
    v_cos_f32 v22, v8
    v_sin_f32 v23, v8
    v_mul_f32 v22, v22, v7
    v_mul_f32 v23, v23, v7
    v_sub_f32 v34, 0, v23
    v_mov_b32 v35, v22
    s_mul_i32 s31, s22, 40960
    s_mul_i32 s26, s23, 10240
    s_add_u32 s26, s26, s31
    v_mul_u32_u24 v13, 160, v1
    v_add_u32 v13, s26, v13
    v_add_f32 v48, v30, v30
    v_add_f32 v49, v31, v31
    v_mov_b32 v66, 1.0
    v_mov_b32 v67, 0
    v_pk_mul_f32 v[50:51], v[14:15], v[48:49] op_sel:[0,0] op_sel_hi:[1,0]
    v_pk_mul_f32 v[68:69], v[22:23], v[66:67] op_sel:[0,0] op_sel_hi:[1,0]
    v_pk_mul_f32 v[82:83], v[18:19], v[48:49] op_sel:[0,0] op_sel_hi:[1,0]
    v_pk_fma_f32 v[50:51], v[16:17], v[48:49], v[50:51] op_sel:[0,1,0] op_sel_hi:[1,1,1]
    v_pk_fma_f32 v[68:69], v[34:35], v[66:67], v[68:69] op_sel:[0,1,0] op_sel_hi:[1,1,1]
    v_pk_fma_f32 v[82:83], v[20:21], v[48:49], v[82:83] op_sel:[0,1,0] op_sel_hi:[1,1,1]
    v_pk_mul_f32 v[54:55], v[14:15], v[50:51] op_sel:[0,0] op_sel_hi:[1,0]
    v_pk_mul_f32 v[70:71], v[22:23], v[68:69] op_sel:[0,0] op_sel_hi:[1,0]
    v_pk_mul_f32 v[84:85], v[18:19], v[50:51] op_sel:[0,0] op_sel_hi:[1,0]
    v_pk_fma_f32 v[54:55], v[16:17], v[50:51], v[54:55] op_sel:[0,1,0] op_sel_hi:[1,1,1]
    v_pk_fma_f32 v[70:71], v[34:35], v[68:69], v[70:71] op_sel:[0,1,0] op_sel_hi:[1,1,1]
    v_pk_fma_f32 v[84:85], v[20:21], v[50:51], v[84:85] op_sel:[0,1,0] op_sel_hi:[1,1,1]
    v_pk_mul_f32 v[56:57], v[14:15], v[54:55] op_sel:[0,0] op_sel_hi:[1,0]
    v_pk_mul_f32 v[72:73], v[22:23], v[70:71] op_sel:[0,0] op_sel_hi:[1,0]
    v_pk_mul_f32 v[86:87], v[18:19], v[54:55] op_sel:[0,0] op_sel_hi:[1,0]
    v_pk_fma_f32 v[56:57], v[16:17], v[54:55], v[56:57] op_sel:[0,1,0] op_sel_hi:[1,1,1]
    v_pk_fma_f32 v[72:73], v[34:35], v[70:71], v[72:73] op_sel:[0,1,0] op_sel_hi:[1,1,1]
    v_pk_fma_f32 v[86:87], v[20:21], v[54:55], v[86:87] op_sel:[0,1,0] op_sel_hi:[1,1,1]
    v_pk_mul_f32 v[58:59], v[14:15], v[56:57] op_sel:[0,0] op_sel_hi:[1,0]
    v_pk_mul_f32 v[74:75], v[22:23], v[72:73] op_sel:[0,0] op_sel_hi:[1,0]
    v_pk_mul_f32 v[88:89], v[18:19], v[56:57] op_sel:[0,0] op_sel_hi:[1,0]
    v_pk_fma_f32 v[58:59], v[16:17], v[56:57], v[58:59] op_sel:[0,1,0] op_sel_hi:[1,1,1]
    v_pk_fma_f32 v[74:75], v[34:35], v[72:73], v[74:75] op_sel:[0,1,0] op_sel_hi:[1,1,1]
    v_pk_fma_f32 v[88:89], v[20:21], v[56:57], v[88:89] op_sel:[0,1,0] op_sel_hi:[1,1,1]
    v_pk_mul_f32 v[60:61], v[14:15], v[58:59] op_sel:[0,0] op_sel_hi:[1,0]
    v_pk_mul_f32 v[76:77], v[22:23], v[74:75] op_sel:[0,0] op_sel_hi:[1,0]
    v_pk_fma_f32 v[60:61], v[16:17], v[58:59], v[60:61] op_sel:[0,1,0] op_sel_hi:[1,1,1]
    v_pk_fma_f32 v[76:77], v[34:35], v[74:75], v[76:77] op_sel:[0,1,0] op_sel_hi:[1,1,1]
    v_pk_mul_f32 v[62:63], v[14:15], v[60:61] op_sel:[0,0] op_sel_hi:[1,0]
    v_pk_mul_f32 v[78:79], v[22:23], v[76:77] op_sel:[0,0] op_sel_hi:[1,0]
    v_pk_fma_f32 v[62:63], v[16:17], v[60:61], v[62:63] op_sel:[0,1,0] op_sel_hi:[1,1,1]
    v_pk_fma_f32 v[78:79], v[34:35], v[76:77], v[78:79] op_sel:[0,1,0] op_sel_hi:[1,1,1]
    v_pk_mul_f32 v[64:65], v[14:15], v[62:63] op_sel:[0,0] op_sel_hi:[1,0]
    v_pk_mul_f32 v[80:81], v[22:23], v[78:79] op_sel:[0,0] op_sel_hi:[1,0]
    v_pk_fma_f32 v[64:65], v[16:17], v[62:63], v[64:65] op_sel:[0,1,0] op_sel_hi:[1,1,1]
    v_pk_fma_f32 v[80:81], v[34:35], v[78:79], v[80:81] op_sel:[0,1,0] op_sel_hi:[1,1,1]
    v_cvt_pk_bf16_f32 v92, v48, v50
    v_cvt_pk_bf16_f32 v93, v54, v56
    v_cvt_pk_bf16_f32 v94, v58, v60
    v_cvt_pk_bf16_f32 v95, v62, v64
    v_cvt_pk_bf16_f32 v96, -v49, -v51
    v_cvt_pk_bf16_f32 v97, -v55, -v57
    v_cvt_pk_bf16_f32 v98, -v59, -v61
    v_cvt_pk_bf16_f32 v99, -v63, -v65
    ds_write_b128 v13, v[92:95] offset:0
    ds_write_b128 v13, v[96:99] offset:20480
    v_cvt_pk_bf16_f32 v100, v66, v68
    v_cvt_pk_bf16_f32 v101, v70, v72
    v_cvt_pk_bf16_f32 v102, v74, v76
    v_cvt_pk_bf16_f32 v103, v78, v80
    v_cvt_pk_bf16_f32 v104, v67, v69
    v_cvt_pk_bf16_f32 v105, v71, v73
    v_cvt_pk_bf16_f32 v106, v75, v77
    v_cvt_pk_bf16_f32 v107, v79, v81
    ds_write_b128 v13, v[100:103] offset:80
    ds_write_b128 v13, v[104:107] offset:20560
    v_pk_mul_f32 v[48:49], v[14:15], v[64:65] op_sel:[0,0] op_sel_hi:[1,0]
    v_pk_mul_f32 v[66:67], v[22:23], v[80:81] op_sel:[0,0] op_sel_hi:[1,0]
    v_pk_fma_f32 v[48:49], v[16:17], v[64:65], v[48:49] op_sel:[0,1,0] op_sel_hi:[1,1,1]
    v_pk_fma_f32 v[66:67], v[34:35], v[80:81], v[66:67] op_sel:[0,1,0] op_sel_hi:[1,1,1]
    v_pk_mul_f32 v[50:51], v[14:15], v[48:49] op_sel:[0,0] op_sel_hi:[1,0]
    v_pk_mul_f32 v[68:69], v[22:23], v[66:67] op_sel:[0,0] op_sel_hi:[1,0]
    v_pk_fma_f32 v[50:51], v[16:17], v[48:49], v[50:51] op_sel:[0,1,0] op_sel_hi:[1,1,1]
    v_pk_fma_f32 v[68:69], v[34:35], v[66:67], v[68:69] op_sel:[0,1,0] op_sel_hi:[1,1,1]
    v_pk_mul_f32 v[54:55], v[14:15], v[50:51] op_sel:[0,0] op_sel_hi:[1,0]
    v_pk_mul_f32 v[70:71], v[22:23], v[68:69] op_sel:[0,0] op_sel_hi:[1,0]
    v_pk_fma_f32 v[54:55], v[16:17], v[50:51], v[54:55] op_sel:[0,1,0] op_sel_hi:[1,1,1]
    v_pk_fma_f32 v[70:71], v[34:35], v[68:69], v[70:71] op_sel:[0,1,0] op_sel_hi:[1,1,1]
    v_pk_mul_f32 v[56:57], v[14:15], v[54:55] op_sel:[0,0] op_sel_hi:[1,0]
    v_pk_mul_f32 v[72:73], v[22:23], v[70:71] op_sel:[0,0] op_sel_hi:[1,0]
    v_pk_fma_f32 v[56:57], v[16:17], v[54:55], v[56:57] op_sel:[0,1,0] op_sel_hi:[1,1,1]
    v_pk_fma_f32 v[72:73], v[34:35], v[70:71], v[72:73] op_sel:[0,1,0] op_sel_hi:[1,1,1]
    v_pk_mul_f32 v[58:59], v[14:15], v[56:57] op_sel:[0,0] op_sel_hi:[1,0]
    v_pk_mul_f32 v[74:75], v[22:23], v[72:73] op_sel:[0,0] op_sel_hi:[1,0]
    v_pk_fma_f32 v[58:59], v[16:17], v[56:57], v[58:59] op_sel:[0,1,0] op_sel_hi:[1,1,1]
    v_pk_fma_f32 v[74:75], v[34:35], v[72:73], v[74:75] op_sel:[0,1,0] op_sel_hi:[1,1,1]
    v_pk_mul_f32 v[60:61], v[14:15], v[58:59] op_sel:[0,0] op_sel_hi:[1,0]
    v_pk_mul_f32 v[76:77], v[22:23], v[74:75] op_sel:[0,0] op_sel_hi:[1,0]
    v_pk_fma_f32 v[60:61], v[16:17], v[58:59], v[60:61] op_sel:[0,1,0] op_sel_hi:[1,1,1]
    v_pk_fma_f32 v[76:77], v[34:35], v[74:75], v[76:77] op_sel:[0,1,0] op_sel_hi:[1,1,1]
    v_pk_mul_f32 v[62:63], v[14:15], v[60:61] op_sel:[0,0] op_sel_hi:[1,0]
    v_pk_mul_f32 v[78:79], v[22:23], v[76:77] op_sel:[0,0] op_sel_hi:[1,0]
    v_pk_fma_f32 v[62:63], v[16:17], v[60:61], v[62:63] op_sel:[0,1,0] op_sel_hi:[1,1,1]
    v_pk_fma_f32 v[78:79], v[34:35], v[76:77], v[78:79] op_sel:[0,1,0] op_sel_hi:[1,1,1]
    v_pk_mul_f32 v[64:65], v[14:15], v[62:63] op_sel:[0,0] op_sel_hi:[1,0]
    v_pk_mul_f32 v[80:81], v[22:23], v[78:79] op_sel:[0,0] op_sel_hi:[1,0]
    v_pk_fma_f32 v[64:65], v[16:17], v[62:63], v[64:65] op_sel:[0,1,0] op_sel_hi:[1,1,1]
    v_pk_fma_f32 v[80:81], v[34:35], v[78:79], v[80:81] op_sel:[0,1,0] op_sel_hi:[1,1,1]
    v_cvt_pk_bf16_f32 v92, v48, v50
    v_cvt_pk_bf16_f32 v93, v54, v56
    v_cvt_pk_bf16_f32 v94, v58, v60
    v_cvt_pk_bf16_f32 v95, v62, v64
    v_cvt_pk_bf16_f32 v96, -v49, -v51
    v_cvt_pk_bf16_f32 v97, -v55, -v57
    v_cvt_pk_bf16_f32 v98, -v59, -v61
    v_cvt_pk_bf16_f32 v99, -v63, -v65
    ds_write_b128 v13, v[92:95] offset:16
    ds_write_b128 v13, v[96:99] offset:20496
    v_cvt_pk_bf16_f32 v100, v66, v68
    v_cvt_pk_bf16_f32 v101, v70, v72
    v_cvt_pk_bf16_f32 v102, v74, v76
    v_cvt_pk_bf16_f32 v103, v78, v80
    v_cvt_pk_bf16_f32 v104, v67, v69
    v_cvt_pk_bf16_f32 v105, v71, v73
    v_cvt_pk_bf16_f32 v106, v75, v77
    v_cvt_pk_bf16_f32 v107, v79, v81
    ds_write_b128 v13, v[100:103] offset:96
    ds_write_b128 v13, v[104:107] offset:20576
    s_waitcnt vmcnt(8)
    ds_write_b128 v52, v[36:39]
    ds_write_b128 v52, v[40:43] offset:4608
    s_waitcnt vmcnt(2)
    s_waitcnt lgkmcnt(0)
    s_barrier
    s_cmp_eq_u32 s20, 1
    s_cbranch_scc0 sequential_preLN__ssm_conv_s4d__dense_activation_gelu__prompt_kernel_nw6
    v_mov_b32 v7, s51
    s_mov_b32 s7, 0
    s_mov_b64 exec, 0xff
    buffer_store_dword v7, v3, s[8:11], s7 offen sc1
    s_mov_b64 exec, -1
sequential_preLN__ssm_conv_s4d__dense_activation_gelu__prompt_kernel_nw6:
    ds_read_b64_tr_b16 v[108:109], v53 offset:0
    ds_read_b64_tr_b16 v[110:111], v53 offset:4608
    ds_read_b64_tr_b16 v[116:117], v53 offset:32
    ds_read_b64_tr_b16 v[118:119], v53 offset:4640
    s_lshl_b32 s26, s5, 1
    s_add_u32 s26, s26, s22
    s_lshl_b32 s26, s26, 18
    s_lshl_b32 s27, s4, 12
    s_add_u32 s26, s26, s27
    s_lshl_b32 s27, s23, 11
    s_add_u32 s26, s26, s27
    s_add_u32 s26, s26, 6291456
    s_waitcnt lgkmcnt(2)
    v_or_b32 v111, s50, v111
    buffer_store_dwordx4 v[108:111], v2, s[8:11], s26 offen offset:0 sc1
    s_waitcnt lgkmcnt(0)
    v_or_b32 v119, s50, v119
    buffer_store_dwordx4 v[116:119], v2, s[8:11], s26 offen offset:1024 sc1
    v_pk_mul_f32 v[48:49], v[14:15], v[64:65] op_sel:[0,0] op_sel_hi:[1,0]
    v_pk_mul_f32 v[66:67], v[22:23], v[80:81] op_sel:[0,0] op_sel_hi:[1,0]
    v_pk_fma_f32 v[48:49], v[16:17], v[64:65], v[48:49] op_sel:[0,1,0] op_sel_hi:[1,1,1]
    v_pk_fma_f32 v[66:67], v[34:35], v[80:81], v[66:67] op_sel:[0,1,0] op_sel_hi:[1,1,1]
    v_pk_mul_f32 v[50:51], v[14:15], v[48:49] op_sel:[0,0] op_sel_hi:[1,0]
    v_pk_mul_f32 v[68:69], v[22:23], v[66:67] op_sel:[0,0] op_sel_hi:[1,0]
    v_pk_fma_f32 v[50:51], v[16:17], v[48:49], v[50:51] op_sel:[0,1,0] op_sel_hi:[1,1,1]
    v_pk_fma_f32 v[68:69], v[34:35], v[66:67], v[68:69] op_sel:[0,1,0] op_sel_hi:[1,1,1]
    v_pk_mul_f32 v[54:55], v[14:15], v[50:51] op_sel:[0,0] op_sel_hi:[1,0]
    v_pk_mul_f32 v[70:71], v[22:23], v[68:69] op_sel:[0,0] op_sel_hi:[1,0]
    v_pk_fma_f32 v[54:55], v[16:17], v[50:51], v[54:55] op_sel:[0,1,0] op_sel_hi:[1,1,1]
    v_pk_fma_f32 v[70:71], v[34:35], v[68:69], v[70:71] op_sel:[0,1,0] op_sel_hi:[1,1,1]
    v_pk_mul_f32 v[56:57], v[14:15], v[54:55] op_sel:[0,0] op_sel_hi:[1,0]
    v_pk_mul_f32 v[72:73], v[22:23], v[70:71] op_sel:[0,0] op_sel_hi:[1,0]
    v_pk_fma_f32 v[56:57], v[16:17], v[54:55], v[56:57] op_sel:[0,1,0] op_sel_hi:[1,1,1]
    v_pk_fma_f32 v[72:73], v[34:35], v[70:71], v[72:73] op_sel:[0,1,0] op_sel_hi:[1,1,1]
    v_pk_mul_f32 v[58:59], v[14:15], v[56:57] op_sel:[0,0] op_sel_hi:[1,0]
    v_pk_mul_f32 v[74:75], v[22:23], v[72:73] op_sel:[0,0] op_sel_hi:[1,0]
    v_pk_fma_f32 v[58:59], v[16:17], v[56:57], v[58:59] op_sel:[0,1,0] op_sel_hi:[1,1,1]
    v_pk_fma_f32 v[74:75], v[34:35], v[72:73], v[74:75] op_sel:[0,1,0] op_sel_hi:[1,1,1]
    v_pk_mul_f32 v[60:61], v[14:15], v[58:59] op_sel:[0,0] op_sel_hi:[1,0]
    v_pk_mul_f32 v[76:77], v[22:23], v[74:75] op_sel:[0,0] op_sel_hi:[1,0]
    v_pk_fma_f32 v[60:61], v[16:17], v[58:59], v[60:61] op_sel:[0,1,0] op_sel_hi:[1,1,1]
    v_pk_fma_f32 v[76:77], v[34:35], v[74:75], v[76:77] op_sel:[0,1,0] op_sel_hi:[1,1,1]
    v_pk_mul_f32 v[62:63], v[14:15], v[60:61] op_sel:[0,0] op_sel_hi:[1,0]
    v_pk_mul_f32 v[78:79], v[22:23], v[76:77] op_sel:[0,0] op_sel_hi:[1,0]
    v_pk_fma_f32 v[62:63], v[16:17], v[60:61], v[62:63] op_sel:[0,1,0] op_sel_hi:[1,1,1]
    v_pk_fma_f32 v[78:79], v[34:35], v[76:77], v[78:79] op_sel:[0,1,0] op_sel_hi:[1,1,1]
    v_pk_mul_f32 v[64:65], v[14:15], v[62:63] op_sel:[0,0] op_sel_hi:[1,0]
    v_pk_mul_f32 v[80:81], v[22:23], v[78:79] op_sel:[0,0] op_sel_hi:[1,0]
    v_pk_fma_f32 v[64:65], v[16:17], v[62:63], v[64:65] op_sel:[0,1,0] op_sel_hi:[1,1,1]
    v_pk_fma_f32 v[80:81], v[34:35], v[78:79], v[80:81] op_sel:[0,1,0] op_sel_hi:[1,1,1]
    v_cvt_pk_bf16_f32 v92, v48, v50
    v_cvt_pk_bf16_f32 v93, v54, v56
    v_cvt_pk_bf16_f32 v94, v58, v60
    v_cvt_pk_bf16_f32 v95, v62, v64
    v_cvt_pk_bf16_f32 v96, -v49, -v51
    v_cvt_pk_bf16_f32 v97, -v55, -v57
    v_cvt_pk_bf16_f32 v98, -v59, -v61
    v_cvt_pk_bf16_f32 v99, -v63, -v65
    ds_write_b128 v13, v[92:95] offset:32
    ds_write_b128 v13, v[96:99] offset:20512
    v_cvt_pk_bf16_f32 v100, v66, v68
    v_cvt_pk_bf16_f32 v101, v70, v72
    v_cvt_pk_bf16_f32 v102, v74, v76
    v_cvt_pk_bf16_f32 v103, v78, v80
    v_cvt_pk_bf16_f32 v104, v67, v69
    v_cvt_pk_bf16_f32 v105, v71, v73
    v_cvt_pk_bf16_f32 v106, v75, v77
    v_cvt_pk_bf16_f32 v107, v79, v81
    ds_write_b128 v13, v[100:103] offset:112
    ds_write_b128 v13, v[104:107] offset:20592
    v_pk_mul_f32 v[48:49], v[14:15], v[64:65] op_sel:[0,0] op_sel_hi:[1,0]
    v_pk_mul_f32 v[66:67], v[22:23], v[80:81] op_sel:[0,0] op_sel_hi:[1,0]
    v_pk_fma_f32 v[48:49], v[16:17], v[64:65], v[48:49] op_sel:[0,1,0] op_sel_hi:[1,1,1]
    v_pk_fma_f32 v[66:67], v[34:35], v[80:81], v[66:67] op_sel:[0,1,0] op_sel_hi:[1,1,1]
    v_pk_mul_f32 v[50:51], v[14:15], v[48:49] op_sel:[0,0] op_sel_hi:[1,0]
    v_pk_mul_f32 v[68:69], v[22:23], v[66:67] op_sel:[0,0] op_sel_hi:[1,0]
    v_pk_fma_f32 v[50:51], v[16:17], v[48:49], v[50:51] op_sel:[0,1,0] op_sel_hi:[1,1,1]
    v_pk_fma_f32 v[68:69], v[34:35], v[66:67], v[68:69] op_sel:[0,1,0] op_sel_hi:[1,1,1]
    v_pk_mul_f32 v[54:55], v[14:15], v[50:51] op_sel:[0,0] op_sel_hi:[1,0]
    v_pk_mul_f32 v[70:71], v[22:23], v[68:69] op_sel:[0,0] op_sel_hi:[1,0]
    v_pk_fma_f32 v[54:55], v[16:17], v[50:51], v[54:55] op_sel:[0,1,0] op_sel_hi:[1,1,1]
    v_pk_fma_f32 v[70:71], v[34:35], v[68:69], v[70:71] op_sel:[0,1,0] op_sel_hi:[1,1,1]
    v_pk_mul_f32 v[56:57], v[14:15], v[54:55] op_sel:[0,0] op_sel_hi:[1,0]
    v_pk_mul_f32 v[72:73], v[22:23], v[70:71] op_sel:[0,0] op_sel_hi:[1,0]
    v_pk_fma_f32 v[56:57], v[16:17], v[54:55], v[56:57] op_sel:[0,1,0] op_sel_hi:[1,1,1]
    v_pk_fma_f32 v[72:73], v[34:35], v[70:71], v[72:73] op_sel:[0,1,0] op_sel_hi:[1,1,1]
    v_pk_mul_f32 v[58:59], v[14:15], v[56:57] op_sel:[0,0] op_sel_hi:[1,0]
    v_pk_mul_f32 v[74:75], v[22:23], v[72:73] op_sel:[0,0] op_sel_hi:[1,0]
    v_pk_fma_f32 v[58:59], v[16:17], v[56:57], v[58:59] op_sel:[0,1,0] op_sel_hi:[1,1,1]
    v_pk_fma_f32 v[74:75], v[34:35], v[72:73], v[74:75] op_sel:[0,1,0] op_sel_hi:[1,1,1]
    v_pk_mul_f32 v[60:61], v[14:15], v[58:59] op_sel:[0,0] op_sel_hi:[1,0]
    v_pk_mul_f32 v[76:77], v[22:23], v[74:75] op_sel:[0,0] op_sel_hi:[1,0]
    v_pk_fma_f32 v[60:61], v[16:17], v[58:59], v[60:61] op_sel:[0,1,0] op_sel_hi:[1,1,1]
    v_pk_fma_f32 v[76:77], v[34:35], v[74:75], v[76:77] op_sel:[0,1,0] op_sel_hi:[1,1,1]
    v_pk_mul_f32 v[62:63], v[14:15], v[60:61] op_sel:[0,0] op_sel_hi:[1,0]
    v_pk_mul_f32 v[78:79], v[22:23], v[76:77] op_sel:[0,0] op_sel_hi:[1,0]
    v_pk_fma_f32 v[62:63], v[16:17], v[60:61], v[62:63] op_sel:[0,1,0] op_sel_hi:[1,1,1]
    v_pk_fma_f32 v[78:79], v[34:35], v[76:77], v[78:79] op_sel:[0,1,0] op_sel_hi:[1,1,1]
    v_pk_mul_f32 v[64:65], v[14:15], v[62:63] op_sel:[0,0] op_sel_hi:[1,0]
    v_pk_mul_f32 v[80:81], v[22:23], v[78:79] op_sel:[0,0] op_sel_hi:[1,0]
    v_pk_fma_f32 v[64:65], v[16:17], v[62:63], v[64:65] op_sel:[0,1,0] op_sel_hi:[1,1,1]
    v_pk_fma_f32 v[80:81], v[34:35], v[78:79], v[80:81] op_sel:[0,1,0] op_sel_hi:[1,1,1]
    v_cvt_pk_bf16_f32 v92, v48, v50
    v_cvt_pk_bf16_f32 v93, v54, v56
    v_cvt_pk_bf16_f32 v94, v58, v60
    v_cvt_pk_bf16_f32 v95, v62, v64
    v_cvt_pk_bf16_f32 v96, -v49, -v51
    v_cvt_pk_bf16_f32 v97, -v55, -v57
    v_cvt_pk_bf16_f32 v98, -v59, -v61
    v_cvt_pk_bf16_f32 v99, -v63, -v65
    ds_write_b128 v13, v[92:95] offset:48
    ds_write_b128 v13, v[96:99] offset:20528
    v_cvt_pk_bf16_f32 v100, v66, v68
    v_cvt_pk_bf16_f32 v101, v70, v72
    v_cvt_pk_bf16_f32 v102, v74, v76
    v_cvt_pk_bf16_f32 v103, v78, v80
    v_cvt_pk_bf16_f32 v104, v67, v69
    v_cvt_pk_bf16_f32 v105, v71, v73
    v_cvt_pk_bf16_f32 v106, v75, v77
    v_cvt_pk_bf16_f32 v107, v79, v81
    ds_write_b128 v13, v[100:103] offset:128
    ds_write_b128 v13, v[104:107] offset:20608
    v_pk_mul_f32 v[48:49], v[14:15], v[64:65] op_sel:[0,0] op_sel_hi:[1,0]
    s_nop 0
    v_pk_fma_f32 v[48:49], v[16:17], v[64:65], v[48:49] op_sel:[0,1,0] op_sel_hi:[1,1,1]
    s_nop 0
    v_cvt_pk_bf16_f32 v92, v48, v82
    v_cvt_pk_bf16_f32 v93, v84, v86
    v_cvt_pk_bf16_f32 v94, v88, v88
    v_cvt_pk_bf16_f32 v95, v88, v88
    v_cvt_pk_bf16_f32 v96, -v49, -v83
    v_cvt_pk_bf16_f32 v97, -v85, -v87
    v_cvt_pk_bf16_f32 v98, -v89, -v89
    v_cvt_pk_bf16_f32 v99, -v89, -v89
    ds_write_b128 v13, v[92:95] offset:64
    ds_write_b128 v13, v[96:99] offset:20544
    v_lshrrev_b32 v7, 2, v1
    v_mul_u32_u24 v12, 160, v7
    v_and_b32 v8, 3, v1
    v_lshl_add_u32 v12, v8, 3, v12
    v_add_u32 v12, s31, v12
    s_lshl_b32 s26, s23, 5
    s_add_u32 s26, s26, 80
    v_add_u32 v13, s26, v12
    s_waitcnt lgkmcnt(0)
    s_barrier
    ds_read_b64_tr_b16 v[56:57], v13 offset:0
    ds_read_b64_tr_b16 v[58:59], v13 offset:2560
    ds_read_b64_tr_b16 v[28:29], v12 offset:0
    ds_read_b64_tr_b16 v[30:31], v12 offset:2560
    ds_read_b64_tr_b16 v[32:33], v12 offset:32
    ds_read_b64_tr_b16 v[34:35], v12 offset:2592
    ds_read_b64_tr_b16 v[36:37], v12 offset:64
    ds_read_b64_tr_b16 v[38:39], v12 offset:2624
    s_waitcnt lgkmcnt(0)
    ds_read_b64_tr_b16 v[60:61], v13 offset:5120
    ds_read_b64_tr_b16 v[62:63], v13 offset:7680
    ds_read_b64_tr_b16 v[40:41], v12 offset:5120
    v_mfma_f32_16x16x32_bf16 v[16:19], v[56:59], v[28:31], 0
    v_and_b32 v7, 15, v1
    ds_read_b64_tr_b16 v[42:43], v12 offset:7680
    ds_read_b64_tr_b16 v[48:49], v12 offset:5152
    ds_read_b64_tr_b16 v[50:51], v12 offset:7712
    v_mfma_f32_16x16x32_bf16 v[20:23], v[56:59], v[32:35], 0
    v_lshlrev_b32 v14, 6, v7
    ds_read_b64_tr_b16 v[52:53], v12 offset:5184
    ds_read_b64_tr_b16 v[54:55], v12 offset:7744
    v_mfma_f32_16x16x32_bf16 v[24:27], v[56:59], v[36:39], 0
    v_lshrrev_b32 v8, 4, v1
    s_waitcnt lgkmcnt(0)
    ds_read_b64_tr_b16 v[56:57], v13 offset:10240
    ds_read_b64_tr_b16 v[58:59], v13 offset:12800
    ds_read_b64_tr_b16 v[28:29], v12 offset:10240
    v_mfma_f32_16x16x32_bf16 v[16:19], v[60:63], v[40:43], v[16:19]
    v_lshl_add_u32 v14, v8, 3, v14
    ds_read_b64_tr_b16 v[30:31], v12 offset:12800
    ds_read_b64_tr_b16 v[32:33], v12 offset:10272
    ds_read_b64_tr_b16 v[34:35], v12 offset:12832
    v_mfma_f32_16x16x32_bf16 v[20:23], v[60:63], v[48:51], v[20:23]
    s_lshl_b32 s31, s22, 12
    ds_read_b64_tr_b16 v[36:37], v12 offset:10304
    ds_read_b64_tr_b16 v[38:39], v12 offset:12864
    v_mfma_f32_16x16x32_bf16 v[24:27], v[60:63], v[52:55], v[24:27]
    s_add_u32 s31, s31, 92160
    s_waitcnt lgkmcnt(0)
    ds_read_b64_tr_b16 v[60:61], v13 offset:15360
    ds_read_b64_tr_b16 v[62:63], v13 offset:17920
    ds_read_b64_tr_b16 v[40:41], v12 offset:15360
    v_mfma_f32_16x16x32_bf16 v[16:19], v[56:59], v[28:31], v[16:19]
    s_lshl_b32 s26, s23, 5
    ds_read_b64_tr_b16 v[42:43], v12 offset:17920
    ds_read_b64_tr_b16 v[48:49], v12 offset:15392
    ds_read_b64_tr_b16 v[50:51], v12 offset:17952
    v_mfma_f32_16x16x32_bf16 v[20:23], v[56:59], v[32:35], v[20:23]
    s_add_u32 s26, s26, s31
    ds_read_b64_tr_b16 v[52:53], v12 offset:15424
    ds_read_b64_tr_b16 v[54:55], v12 offset:17984
    v_mfma_f32_16x16x32_bf16 v[24:27], v[56:59], v[36:39], v[24:27]
    v_add_u32 v14, s26, v14
    s_waitcnt lgkmcnt(0)
    ds_read_b64_tr_b16 v[56:57], v13 offset:20480
    ds_read_b64_tr_b16 v[58:59], v13 offset:23040
    ds_read_b64_tr_b16 v[28:29], v12 offset:20480
    v_mfma_f32_16x16x32_bf16 v[16:19], v[60:63], v[40:43], v[16:19]
    v_mov_b32 v76, s31
    ds_read_b64_tr_b16 v[30:31], v12 offset:23040
    ds_read_b64_tr_b16 v[32:33], v12 offset:20512
    ds_read_b64_tr_b16 v[34:35], v12 offset:23072
    v_mfma_f32_16x16x32_bf16 v[20:23], v[60:63], v[48:51], v[20:23]
    v_mov_b32 v77, 0
    ds_read_b64_tr_b16 v[36:37], v12 offset:20544
    ds_read_b64_tr_b16 v[38:39], v12 offset:23104
    v_mfma_f32_16x16x32_bf16 v[24:27], v[60:63], v[52:55], v[24:27]
    v_mov_b32 v9, 92160
    s_waitcnt lgkmcnt(0)
    ds_read_b64_tr_b16 v[60:61], v13 offset:25600
    ds_read_b64_tr_b16 v[62:63], v13 offset:28160
    ds_read_b64_tr_b16 v[40:41], v12 offset:25600
    v_mfma_f32_16x16x32_bf16 v[16:19], v[56:59], v[28:31], v[16:19]
    s_waitcnt vmcnt(2)
    ds_read_b64_tr_b16 v[42:43], v12 offset:28160
    ds_read_b64_tr_b16 v[48:49], v12 offset:25632
    ds_read_b64_tr_b16 v[50:51], v12 offset:28192
    v_mfma_f32_16x16x32_bf16 v[20:23], v[56:59], v[32:35], v[20:23]
    v_add_u32_sdwa v15, v160, v9 dst_sel:DWORD dst_unused:UNUSED_PAD src0_sel:WORD_0 src1_sel:DWORD
    ds_read_b64_tr_b16 v[52:53], v12 offset:25664
    ds_read_b64_tr_b16 v[54:55], v12 offset:28224
    v_mfma_f32_16x16x32_bf16 v[24:27], v[56:59], v[36:39], v[24:27]
    v_add_u32_sdwa v68, v160, v9 dst_sel:DWORD dst_unused:UNUSED_PAD src0_sel:WORD_1 src1_sel:DWORD
    s_waitcnt lgkmcnt(0)
    ds_read_b64_tr_b16 v[56:57], v13 offset:30720
    ds_read_b64_tr_b16 v[58:59], v13 offset:33280
    ds_read_b64_tr_b16 v[28:29], v12 offset:30720
    v_mfma_f32_16x16x32_bf16 v[16:19], v[60:63], v[40:43], v[16:19]
    v_add_u32_sdwa v69, v161, v9 dst_sel:DWORD dst_unused:UNUSED_PAD src0_sel:WORD_0 src1_sel:DWORD
    ds_read_b64_tr_b16 v[30:31], v12 offset:33280
    ds_read_b64_tr_b16 v[32:33], v12 offset:30752
    ds_read_b64_tr_b16 v[34:35], v12 offset:33312
    v_mfma_f32_16x16x32_bf16 v[20:23], v[60:63], v[48:51], v[20:23]
    v_add_u32_sdwa v70, v161, v9 dst_sel:DWORD dst_unused:UNUSED_PAD src0_sel:WORD_1 src1_sel:DWORD
    ds_read_b64_tr_b16 v[36:37], v12 offset:30784
    ds_read_b64_tr_b16 v[38:39], v12 offset:33344
    v_mfma_f32_16x16x32_bf16 v[24:27], v[60:63], v[52:55], v[24:27]
    v_add_u32_sdwa v71, v162, v9 dst_sel:DWORD dst_unused:UNUSED_PAD src0_sel:WORD_0 src1_sel:DWORD
    s_cmp_eq_u32 s20, 0
    s_cbranch_scc0 sequential_preLN__ssm_conv_s4d__dense_activation_gelu__prompt_kernel_nw7
    buffer_load_dwordx4 v[64:67], v4, s[8:11], 0 offen sc1
sequential_preLN__ssm_conv_s4d__dense_activation_gelu__prompt_kernel_nw7:
    s_waitcnt lgkmcnt(0)
    ds_read_b64_tr_b16 v[60:61], v13 offset:35840
    ds_read_b64_tr_b16 v[62:63], v13 offset:38400
    ds_read_b64_tr_b16 v[40:41], v12 offset:35840
    v_mfma_f32_16x16x32_bf16 v[16:19], v[56:59], v[28:31], v[16:19]
    v_add_u32_sdwa v72, v162, v9 dst_sel:DWORD dst_unused:UNUSED_PAD src0_sel:WORD_1 src1_sel:DWORD
    ds_read_b64_tr_b16 v[42:43], v12 offset:38400
    ds_read_b64_tr_b16 v[48:49], v12 offset:35872
    ds_read_b64_tr_b16 v[50:51], v12 offset:38432
    v_mfma_f32_16x16x32_bf16 v[20:23], v[56:59], v[32:35], v[20:23]
    v_add_u32_sdwa v73, v163, v9 dst_sel:DWORD dst_unused:UNUSED_PAD src0_sel:WORD_0 src1_sel:DWORD
    ds_read_b64_tr_b16 v[52:53], v12 offset:35904
    ds_read_b64_tr_b16 v[54:55], v12 offset:38464
    v_mfma_f32_16x16x32_bf16 v[24:27], v[56:59], v[36:39], v[24:27]
    v_add_u32_sdwa v74, v163, v9 dst_sel:DWORD dst_unused:UNUSED_PAD src0_sel:WORD_1 src1_sel:DWORD
    s_waitcnt lgkmcnt(0)
    v_mfma_f32_16x16x32_bf16 v[16:19], v[60:63], v[40:43], v[16:19]
    v_add_u32 v75, v113, v9
    v_mfma_f32_16x16x32_bf16 v[20:23], v[60:63], v[48:51], v[20:23]
    v_mfma_f32_16x16x32_bf16 v[24:27], v[60:63], v[52:55], v[24:27]
    ds_write_b32 v76, v77 offset:3072
    s_nop 3
    v_cvt_pk_bf16_f32 v78, v16, v17
    v_cvt_pk_bf16_f32 v79, v18, v19
    ds_write_b64 v14, v[78:79] offset:0
    v_cvt_pk_bf16_f32 v80, v20, v21
    v_cvt_pk_bf16_f32 v81, v22, v23
    ds_write_b64 v14, v[80:81] offset:1024
    v_cvt_pk_bf16_f32 v82, v24, v25
    v_cvt_pk_bf16_f32 v83, v26, v27
    ds_write_b64 v14, v[82:83] offset:2048
    v_lshrrev_b32 v7, 2, v0
    v_lshlrev_b32 v12, 14, v7
    v_and_b32 v8, 3, v0
    v_lshl_add_u32 v12, v8, 4, v12
    s_cmp_eq_u32 s20, 0
    s_cbranch_scc0 sequential_preLN__ssm_conv_s4d__dense_activation_gelu__prompt_kernel_nw8
    s_waitcnt vmcnt(0)
    v_bitop3_b32 v7, v64, v65, s51 bitop3:0x7e
    v_bitop3_b32 v8, v66, v67, s51 bitop3:0x7e
    v_or_b32 v7, v7, v8
    v_cmp_ne_u32 vcc, 0, v7
    s_cbranch_vccz sequential_preLN__ssm_conv_s4d__dense_activation_gelu__prompt_kernel_c0ok9
    s_mov_b32 s72, 0
    s_mov_b32 s7, 0
sequential_preLN__ssm_conv_s4d__dense_activation_gelu__prompt_kernel_poll10:
    buffer_load_dwordx4 v[64:67], v4, s[8:11], s7 offen sc1
    s_waitcnt vmcnt(0)
    v_bitop3_b32 v7, v64, v65, s51 bitop3:0x7e
    v_bitop3_b32 v8, v66, v67, s51 bitop3:0x7e
    v_or_b32 v7, v7, v8
    v_cmp_ne_u32 vcc, 0, v7
    s_cbranch_vccz sequential_preLN__ssm_conv_s4d__dense_activation_gelu__prompt_kernel_polld11
    s_add_u32 s72, s72, 1
    s_cmp_lt_u32 s72, 40000
    s_cbranch_scc1 sequential_preLN__ssm_conv_s4d__dense_activation_gelu__prompt_kernel_poll10
sequential_preLN__ssm_conv_s4d__dense_activation_gelu__prompt_kernel_polld11:
sequential_preLN__ssm_conv_s4d__dense_activation_gelu__prompt_kernel_c0ok9:
sequential_preLN__ssm_conv_s4d__dense_activation_gelu__prompt_kernel_nw8:
    s_waitcnt lgkmcnt(0)
    s_barrier
    s_lshl_b32 s26, s71, 5
    s_add_u32 s26, s26, 0
    buffer_load_dwordx4 v[16:19], v12, s[8:11], s26 offen sc1 nt
    s_add_u32 s26, s26, 1048576
    buffer_load_dwordx4 v[20:23], v12, s[8:11], s26 offen sc1 nt
    s_add_u32 s26, s26, 1048576
    buffer_load_dwordx4 v[24:27], v12, s[8:11], s26 offen sc1 nt
    s_add_u32 s26, s26, 1048576
    buffer_load_dwordx4 v[28:31], v12, s[8:11], s26 offen sc1 nt
    s_lshl_b32 s34, s70, 18
    s_lshl_b32 s35, s20, 16
    s_add_u32 s34, s34, s35
    s_add_u32 s34, s34, 6291456
    v_mov_b32 v5, v2
    v_add_u32 v12, 114688, v11
    ds_read_u16 v32, v15
    ds_read_u16 v33, v68
    ds_read_u16 v34, v69
    ds_read_u16 v35, v70
    ds_read_u16 v36, v71
    ds_read_u16 v37, v72
    ds_read_u16 v38, v73
    ds_read_u16 v39, v74
    ds_read_u16 v40, v75
    v_lshrrev_b32 v7, 2, v0
    v_bfe_u32 v9, v0, 1, 1
    v_mul_u32_u24 v13, 17088, v9
    v_lshl_add_u32 v13, v7, 4, v13
    v_and_b32 v9, 1, v0
    v_mul_u32_u24 v9, 4096, v9
    v_sub_u32 v13, v13, v9
    v_add_u32 v13, 119296, v13
    s_waitcnt lgkmcnt(0)
    ds_read_u16 v41, v15 offset:4096
    ds_read_u16 v42, v68 offset:4096
    ds_read_u16 v43, v69 offset:4096
    ds_read_u16 v44, v70 offset:4096
    ds_read_u16 v45, v71 offset:4096
    ds_read_u16 v46, v72 offset:4096
    ds_read_u16 v47, v73 offset:4096
    ds_read_u16 v48, v74 offset:4096
    ds_read_u16 v49, v75 offset:4096
    v_lshl_or_b32 v52, v33, 16, v32
    v_lshl_or_b32 v53, v35, 16, v34
    v_lshl_or_b32 v54, v37, 16, v36
    v_lshl_or_b32 v55, v39, 16, v38
    v_lshl_or_b32 v56, v34, 16, v33
    v_lshl_or_b32 v57, v36, 16, v35
    v_lshl_or_b32 v58, v38, 16, v37
    v_lshl_or_b32 v59, v40, 16, v39
    ds_write_b128 v12, v[52:55] offset:8704
    ds_write_b128 v12, v[56:59] offset:12864
    s_waitcnt lgkmcnt(0)
    v_lshl_or_b32 v52, v42, 16, v41
    v_lshl_or_b32 v53, v44, 16, v43
    v_lshl_or_b32 v54, v46, 16, v45
    v_lshl_or_b32 v55, v48, 16, v47
    v_lshl_or_b32 v56, v43, 16, v42
    v_lshl_or_b32 v57, v45, 16, v44
    v_lshl_or_b32 v58, v47, 16, v46
    v_lshl_or_b32 v59, v49, 16, v48
    ds_write_b128 v12, v[52:55] offset:25792
    ds_write_b128 v12, v[56:59] offset:29952
    s_mov_b32 s12, s52
    s_mov_b32 s13, s53
    s_mov_b32 s14, 0x1c0000
    s_mov_b32 s15, 0x00020000
    s_mov_b32 s24, 4682
    v_add_u32 v7, 0, v1
    v_mul_u32_u24 v8, s24, v7
    v_lshrrev_b32 v8, 16, v8
    v_mul_u32_u24 v10, 14, v8
    v_sub_u32 v10, v7, v10
    v_mul_u32_u24 v8, 3584, v8
    v_lshl_add_u32 v10, v10, 4, v8
    v_subrev_u32 v11, 0, v10
    v_add_u32 v7, 64, v1
    v_mul_u32_u24 v8, s24, v7
    v_lshrrev_b32 v8, 16, v8
    v_mul_u32_u24 v10, 14, v8
    v_sub_u32 v10, v7, v10
    v_mul_u32_u24 v8, 3584, v8
    v_lshl_add_u32 v10, v10, 4, v8
    v_subrev_u32 v12, 1024, v10
    v_add_u32 v7, 128, v1
    v_mul_u32_u24 v8, s24, v7
    v_lshrrev_b32 v8, 16, v8
    v_mul_u32_u24 v10, 14, v8
    v_sub_u32 v10, v7, v10
    v_mul_u32_u24 v8, 3584, v8
    v_lshl_add_u32 v10, v10, 4, v8
    v_subrev_u32 v14, 2048, v10
    v_add_u32 v7, 192, v1
    v_mul_u32_u24 v8, s24, v7
    v_lshrrev_b32 v8, 16, v8
    v_mul_u32_u24 v10, 14, v8
    v_sub_u32 v10, v7, v10
    v_mul_u32_u24 v8, 3584, v8
    v_lshl_add_u32 v10, v10, 4, v8
    v_subrev_u32 v15, 3072, v10
    v_add_u32 v7, 256, v1
    v_mul_u32_u24 v8, s24, v7
    v_lshrrev_b32 v8, 16, v8
    v_mul_u32_u24 v10, 14, v8
    v_sub_u32 v10, v7, v10
    v_mul_u32_u24 v8, 3584, v8
    v_lshl_add_u32 v10, v10, 4, v8
    v_subrev_u32 v32, 0, v10
    v_add_u32 v7, 320, v1
    v_mul_u32_u24 v8, s24, v7
    v_lshrrev_b32 v8, 16, v8
    v_mul_u32_u24 v10, 14, v8
    v_sub_u32 v10, v7, v10
    v_mul_u32_u24 v8, 3584, v8
    v_lshl_add_u32 v10, v10, 4, v8
    v_subrev_u32 v33, 1024, v10
    v_add_u32 v7, 384, v1
    v_mul_u32_u24 v8, s24, v7
    v_lshrrev_b32 v8, 16, v8
    v_mul_u32_u24 v10, 14, v8
    v_sub_u32 v10, v7, v10
    v_mul_u32_u24 v8, 3584, v8
    v_lshl_add_u32 v10, v10, 4, v8
    v_subrev_u32 v34, 2048, v10
    s_mul_i32 s24, s20, 7168
    s_mul_i32 s25, s20, 114688
    s_mul_i32 s28, s67, 224
    s_add_u32 s25, s25, s28
    s_mul_i32 s30, s22, 17088
    s_add_u32 s30, s30, 114688
    s_lshl_b32 s31, s23, 8
    v_and_b32 v7, 15, v1
    v_lshrrev_b32 v8, 4, v1
    v_lshlrev_b32 v35, 5, v7
    v_lshl_add_u32 v35, v8, 4, v35
    s_sub_u32 s26, s30, s31
    s_add_u32 s27, s26, 288
    v_add_u32 v35, s27, v35
    v_sub_u32 v9, 2031, v7
    v_lshrrev_b32 v9, 1, v9
    v_lshlrev_b32 v9, 2, v9
    v_lshl_add_u32 v9, v8, 4, v9
    v_and_b32 v7, 1, v7
    v_mul_u32_u24 v7, 4160, v7
    v_sub_u32 v9, v9, v7
    s_add_u32 s27, s26, 9088
    s_add_u32 s29, s27, 0
    v_add_u32 v36, s29, v9
    s_add_u32 s29, s27, 1024
    v_add_u32 v37, s29, v9
    s_add_u32 s29, s27, 2048
    v_add_u32 v38, s29, v9
    s_add_u32 s29, s27, 3072
    v_add_u32 v39, s29, v9
    s_lshl_b32 s26, s23, 12
    s_add_u32 s27, s30, 8704
    s_add_u32 s29, s27, s26
    v_add_u32 v40, s29, v2
    s_xor_b32 s26, s26, 4096
    s_add_u32 s29, s27, s26
    v_add_u32 v41, s29, v2
    v_and_b32 v7, 15, v1
    v_lshrrev_b32 v8, 4, v1
    v_lshlrev_b32 v42, 5, v7
    v_lshl_add_u32 v42, v8, 3, v42
    s_lshl_b32 s26, s23, 11
    s_add_u32 s26, s26, s30
    v_add_u32 v42, s26, v42
    v_lshrrev_b32 v9, 3, v7
    v_lshlrev_b32 v43, 17, v9
    v_and_b32 v7, 7, v7
    v_lshl_add_u32 v43, v7, 5, v43
    v_lshl_add_u32 v43, v8, 3, v43
    s_lshl_b32 s29, s22, 4
    s_lshr_b32 s3, s3, s29
    s_lshl_b32 s3, s3, 16
    s_add_u32 s31, s71, s22
    s_lshl_b32 s31, s31, 8
    s_add_u32 s31, s31, 8388608
    s_lshl_b32 s26, s23, 20
    s_add_u32 s31, s31, s26
    s_waitcnt vmcnt(3)
    ds_write_b128 v13, v[16:19] offset:0
    s_waitcnt vmcnt(2)
    ds_write_b128 v13, v[20:23] offset:1024
    s_waitcnt vmcnt(1)
    ds_write_b128 v13, v[24:27] offset:2048
    s_waitcnt vmcnt(0)
    ds_write_b128 v13, v[28:31] offset:3072
    s_waitcnt lgkmcnt(0)
    s_barrier
    ds_read2_b32 v[124:125], v39 offset0:176 offset1:177
    ds_read2_b32 v[126:127], v39 offset0:178 offset1:179
    ds_read_b128 v[60:63], v35 offset:192
    ds_read_b128 v[64:67], v35 offset:704
    ds_read_b128 v[68:71], v35 offset:1216
    ds_read_b128 v[72:75], v35 offset:1728
    ds_read_b128 v[76:79], v35 offset:2240
    ds_read_b128 v[80:83], v35 offset:2752
    ds_read_b128 v[84:87], v35 offset:3264
    ds_read_b128 v[88:91], v35 offset:3776
    ds_read2_b32 v[128:129], v39 offset0:48 offset1:49
    ds_read2_b32 v[130:131], v39 offset0:50 offset1:51
    ds_read2_b32 v[132:133], v38 offset0:176 offset1:177
    ds_read2_b32 v[134:135], v38 offset0:178 offset1:179
    ds_read2_b32 v[136:137], v38 offset0:48 offset1:49
    s_add_u32 m0, s24, 0
    s_add_u32 s28, s25, 0
    buffer_load_dwordx4 v11, s[12:15], s28 offen offset:0 lds
    buffer_load_dwordx4 v12, s[12:15], s28 offen offset:1024 lds
    s_waitcnt lgkmcnt(5)
    s_mov_b32 s26, 0xffff0000
    v_mfma_f32_16x16x32_bf16 v[16:19], v[124:127], v[60:63], 0
    ds_read2_b32 v[138:139], v38 offset0:50 offset1:51
    ds_read2_b32 v[140:141], v37 offset0:176 offset1:177
    v_mfma_f32_16x16x32_bf16 v[20:23], v[124:127], v[64:67], 0
    ds_read2_b32 v[142:143], v37 offset0:178 offset1:179
    v_mfma_f32_16x16x32_bf16 v[24:27], v[124:127], v[68:71], 0
    ds_read2_b32 v[144:145], v37 offset0:48 offset1:49
    v_mfma_f32_16x16x32_bf16 v[28:31], v[124:127], v[72:75], 0
    ds_read2_b32 v[146:147], v37 offset0:50 offset1:51
    v_mfma_f32_16x16x32_bf16 v[44:47], v[124:127], v[76:79], 0
    ds_read2_b32 v[148:149], v36 offset0:176 offset1:177
    v_mfma_f32_16x16x32_bf16 v[48:51], v[124:127], v[80:83], 0
    buffer_load_dwordx4 v14, s[12:15], s28 offen offset:2048 lds
    v_mfma_f32_16x16x32_bf16 v[52:55], v[124:127], v[84:87], 0
    ds_read2_b32 v[150:151], v36 offset0:178 offset1:179
    ds_read2_b32 v[152:153], v36 offset0:48 offset1:49
    v_mfma_f32_16x16x32_bf16 v[56:59], v[124:127], v[88:91], 0
    ds_read2_b32 v[154:155], v36 offset0:50 offset1:51
    s_waitcnt lgkmcnt(0)
    v_mfma_f32_16x16x32_bf16 v[20:23], v[128:131], v[60:63], v[20:23]
    ds_read2_b32 v[156:157], v39 offset0:160 offset1:161
    v_mfma_f32_16x16x32_bf16 v[24:27], v[128:131], v[64:67], v[24:27]
    ds_read2_b32 v[158:159], v39 offset0:162 offset1:163
    v_mfma_f32_16x16x32_bf16 v[28:31], v[128:131], v[68:71], v[28:31]
    ds_read_b128 v[92:95], v35 offset:128
    v_mfma_f32_16x16x32_bf16 v[44:47], v[128:131], v[72:75], v[44:47]
    buffer_load_dwordx4 v15, s[12:15], s28 offen offset:3072 lds
    v_mfma_f32_16x16x32_bf16 v[48:51], v[128:131], v[76:79], v[48:51]
    ds_read_b128 v[96:99], v35 offset:640
    v_mfma_f32_16x16x32_bf16 v[52:55], v[128:131], v[80:83], v[52:55]
    ds_read_b128 v[100:103], v35 offset:1152
    v_mfma_f32_16x16x32_bf16 v[56:59], v[128:131], v[84:87], v[56:59]
    ds_read_b128 v[104:107], v35 offset:1664
    v_mfma_f32_16x16x32_bf16 v[24:27], v[132:135], v[60:63], v[24:27]
    ds_read_b128 v[108:111], v35 offset:2176
    v_mfma_f32_16x16x32_bf16 v[28:31], v[132:135], v[64:67], v[28:31]
    ds_read_b128 v[112:115], v35 offset:2688
    v_mfma_f32_16x16x32_bf16 v[44:47], v[132:135], v[68:71], v[44:47]
    s_add_u32 m0, s24, 4096
    s_nop 0
    buffer_load_dwordx4 v32, s[12:15], s28 offen offset:0 lds
    v_mfma_f32_16x16x32_bf16 v[48:51], v[132:135], v[72:75], v[48:51]
    ds_read_b128 v[116:119], v35 offset:3200
    v_mfma_f32_16x16x32_bf16 v[52:55], v[132:135], v[76:79], v[52:55]
    ds_read_b128 v[120:123], v35 offset:3712
    v_mfma_f32_16x16x32_bf16 v[56:59], v[132:135], v[80:83], v[56:59]
    ds_read2_b32 v[160:161], v39 offset0:32 offset1:33
    v_mfma_f32_16x16x32_bf16 v[28:31], v[136:139], v[60:63], v[28:31]
    ds_read2_b32 v[162:163], v39 offset0:34 offset1:35
    v_mfma_f32_16x16x32_bf16 v[44:47], v[136:139], v[64:67], v[44:47]
    ds_read2_b32 v[164:165], v38 offset0:160 offset1:161
    v_mfma_f32_16x16x32_bf16 v[48:51], v[136:139], v[68:71], v[48:51]
    buffer_load_dwordx4 v33, s[12:15], s28 offen offset:1024 lds
    v_mfma_f32_16x16x32_bf16 v[52:55], v[136:139], v[72:75], v[52:55]
    ds_read2_b32 v[166:167], v38 offset0:162 offset1:163
    v_mfma_f32_16x16x32_bf16 v[56:59], v[136:139], v[76:79], v[56:59]
    ds_read2_b32 v[168:169], v38 offset0:32 offset1:33
    v_mfma_f32_16x16x32_bf16 v[44:47], v[140:143], v[60:63], v[44:47]
    ds_read2_b32 v[170:171], v38 offset0:34 offset1:35
    v_mfma_f32_16x16x32_bf16 v[48:51], v[140:143], v[64:67], v[48:51]
    ds_read2_b32 v[172:173], v37 offset0:160 offset1:161
    v_mfma_f32_16x16x32_bf16 v[52:55], v[140:143], v[68:71], v[52:55]
    ds_read2_b32 v[174:175], v37 offset0:162 offset1:163
    v_mfma_f32_16x16x32_bf16 v[56:59], v[140:143], v[72:75], v[56:59]
    buffer_load_dwordx4 v34, s[12:15], s28 offen offset:2048 lds
    v_mfma_f32_16x16x32_bf16 v[48:51], v[144:147], v[60:63], v[48:51]
    ds_read2_b32 v[176:177], v37 offset0:32 offset1:33
    v_mfma_f32_16x16x32_bf16 v[52:55], v[144:147], v[64:67], v[52:55]
    ds_read2_b32 v[178:179], v37 offset0:34 offset1:35
    v_mfma_f32_16x16x32_bf16 v[56:59], v[144:147], v[68:71], v[56:59]
    ds_read2_b32 v[180:181], v36 offset0:160 offset1:161
    v_mfma_f32_16x16x32_bf16 v[52:55], v[148:151], v[60:63], v[52:55]
    ds_read2_b32 v[182:183], v36 offset0:162 offset1:163
    v_mfma_f32_16x16x32_bf16 v[56:59], v[148:151], v[64:67], v[56:59]
    ds_read2_b32 v[184:185], v36 offset0:32 offset1:33
    v_mfma_f32_16x16x32_bf16 v[56:59], v[152:155], v[60:63], v[56:59]
    s_add_u32 m0, s24, 28672
    s_add_u32 s28, s25, 458752
    buffer_load_dwordx4 v11, s[12:15], s28 offen offset:0 lds
    ds_read2_b32 v[186:187], v36 offset0:34 offset1:35
    s_waitcnt lgkmcnt(0)
    v_mfma_f32_16x16x32_bf16 v[16:19], v[156:159], v[92:95], v[16:19]
    ds_read2_b32 v[124:125], v39 offset0:144 offset1:145
    v_mfma_f32_16x16x32_bf16 v[20:23], v[156:159], v[96:99], v[20:23]
    ds_read2_b32 v[126:127], v39 offset0:146 offset1:147
    v_mfma_f32_16x16x32_bf16 v[24:27], v[156:159], v[100:103], v[24:27]
    ds_read_b128 v[60:63], v35 offset:64
    v_mfma_f32_16x16x32_bf16 v[28:31], v[156:159], v[104:107], v[28:31]
    ds_read_b128 v[64:67], v35 offset:576
    v_mfma_f32_16x16x32_bf16 v[44:47], v[156:159], v[108:111], v[44:47]
    ds_read_b128 v[68:71], v35 offset:1088
    v_mfma_f32_16x16x32_bf16 v[48:51], v[156:159], v[112:115], v[48:51]
    buffer_load_dwordx4 v12, s[12:15], s28 offen offset:1024 lds
    v_mfma_f32_16x16x32_bf16 v[52:55], v[156:159], v[116:119], v[52:55]
    ds_read_b128 v[72:75], v35 offset:1600
    v_mfma_f32_16x16x32_bf16 v[56:59], v[156:159], v[120:123], v[56:59]
    ds_read_b128 v[76:79], v35 offset:2112
    v_mfma_f32_16x16x32_bf16 v[20:23], v[160:163], v[92:95], v[20:23]
    ds_read_b128 v[80:83], v35 offset:2624
    v_mfma_f32_16x16x32_bf16 v[24:27], v[160:163], v[96:99], v[24:27]
    ds_read_b128 v[84:87], v35 offset:3136
    v_mfma_f32_16x16x32_bf16 v[28:31], v[160:163], v[100:103], v[28:31]
    ds_read_b128 v[88:91], v35 offset:3648
    v_mfma_f32_16x16x32_bf16 v[44:47], v[160:163], v[104:107], v[44:47]
    buffer_load_dwordx4 v14, s[12:15], s28 offen offset:2048 lds
    v_mfma_f32_16x16x32_bf16 v[48:51], v[160:163], v[108:111], v[48:51]
    ds_read2_b32 v[128:129], v39 offset0:16 offset1:17
    v_mfma_f32_16x16x32_bf16 v[52:55], v[160:163], v[112:115], v[52:55]
    ds_read2_b32 v[130:131], v39 offset0:18 offset1:19
    v_mfma_f32_16x16x32_bf16 v[56:59], v[160:163], v[116:119], v[56:59]
    ds_read2_b32 v[132:133], v38 offset0:144 offset1:145
    v_mfma_f32_16x16x32_bf16 v[24:27], v[164:167], v[92:95], v[24:27]
    ds_read2_b32 v[134:135], v38 offset0:146 offset1:147
    v_mfma_f32_16x16x32_bf16 v[28:31], v[164:167], v[96:99], v[28:31]
    ds_read2_b32 v[136:137], v38 offset0:16 offset1:17
    v_mfma_f32_16x16x32_bf16 v[44:47], v[164:167], v[100:103], v[44:47]
    buffer_load_dwordx4 v15, s[12:15], s28 offen offset:3072 lds
    v_mfma_f32_16x16x32_bf16 v[48:51], v[164:167], v[104:107], v[48:51]
    ds_read2_b32 v[138:139], v38 offset0:18 offset1:19
    v_mfma_f32_16x16x32_bf16 v[52:55], v[164:167], v[108:111], v[52:55]
    ds_read2_b32 v[140:141], v37 offset0:144 offset1:145
    v_mfma_f32_16x16x32_bf16 v[56:59], v[164:167], v[112:115], v[56:59]
    ds_read2_b32 v[142:143], v37 offset0:146 offset1:147
    v_mfma_f32_16x16x32_bf16 v[28:31], v[168:171], v[92:95], v[28:31]
    ds_read2_b32 v[144:145], v37 offset0:16 offset1:17
    v_mfma_f32_16x16x32_bf16 v[44:47], v[168:171], v[96:99], v[44:47]
    ds_read2_b32 v[146:147], v37 offset0:18 offset1:19
    v_mfma_f32_16x16x32_bf16 v[48:51], v[168:171], v[100:103], v[48:51]
    s_add_u32 m0, s24, 32768
    s_nop 0
    buffer_load_dwordx4 v32, s[12:15], s28 offen offset:0 lds
    v_mfma_f32_16x16x32_bf16 v[52:55], v[168:171], v[104:107], v[52:55]
    ds_read2_b32 v[148:149], v36 offset0:144 offset1:145
    v_mfma_f32_16x16x32_bf16 v[56:59], v[168:171], v[108:111], v[56:59]
    ds_read2_b32 v[150:151], v36 offset0:146 offset1:147
    v_mfma_f32_16x16x32_bf16 v[44:47], v[172:175], v[92:95], v[44:47]
    ds_read2_b32 v[152:153], v36 offset0:16 offset1:17
    v_mfma_f32_16x16x32_bf16 v[48:51], v[172:175], v[96:99], v[48:51]
    ds_read2_b32 v[154:155], v36 offset0:18 offset1:19
    v_mfma_f32_16x16x32_bf16 v[52:55], v[172:175], v[100:103], v[52:55]
    v_mfma_f32_16x16x32_bf16 v[56:59], v[172:175], v[104:107], v[56:59]
    buffer_load_dwordx4 v33, s[12:15], s28 offen offset:1024 lds
    v_mfma_f32_16x16x32_bf16 v[48:51], v[176:179], v[92:95], v[48:51]
    v_mfma_f32_16x16x32_bf16 v[52:55], v[176:179], v[96:99], v[52:55]
    v_mfma_f32_16x16x32_bf16 v[56:59], v[176:179], v[100:103], v[56:59]
    v_mfma_f32_16x16x32_bf16 v[52:55], v[180:183], v[92:95], v[52:55]
    v_mfma_f32_16x16x32_bf16 v[56:59], v[180:183], v[96:99], v[56:59]
    v_mfma_f32_16x16x32_bf16 v[56:59], v[184:187], v[92:95], v[56:59]
    buffer_load_dwordx4 v34, s[12:15], s28 offen offset:2048 lds
    s_waitcnt lgkmcnt(0)
    v_mfma_f32_16x16x32_bf16 v[16:19], v[124:127], v[60:63], v[16:19]
    ds_read2_b32 v[156:157], v39 offset0:128 offset1:129
    v_mfma_f32_16x16x32_bf16 v[20:23], v[124:127], v[64:67], v[20:23]
    ds_read2_b32 v[158:159], v39 offset0:130 offset1:131
    v_mfma_f32_16x16x32_bf16 v[24:27], v[124:127], v[68:71], v[24:27]
    ds_read_b128 v[92:95], v35 offset:0
    v_mfma_f32_16x16x32_bf16 v[28:31], v[124:127], v[72:75], v[28:31]
    ds_read_b128 v[96:99], v35 offset:512
    v_mfma_f32_16x16x32_bf16 v[44:47], v[124:127], v[76:79], v[44:47]
    ds_read_b128 v[100:103], v35 offset:1024
    v_mfma_f32_16x16x32_bf16 v[48:51], v[124:127], v[80:83], v[48:51]
    s_add_u32 m0, s24, 57344
    s_add_u32 s28, s25, 917504
    buffer_load_dwordx4 v11, s[12:15], s28 offen offset:0 lds
    v_mfma_f32_16x16x32_bf16 v[52:55], v[124:127], v[84:87], v[52:55]
    ds_read_b128 v[104:107], v35 offset:1536
    v_mfma_f32_16x16x32_bf16 v[56:59], v[124:127], v[88:91], v[56:59]
    ds_read_b128 v[108:111], v35 offset:2048
    v_mfma_f32_16x16x32_bf16 v[20:23], v[128:131], v[60:63], v[20:23]
    ds_read_b128 v[112:115], v35 offset:2560
    v_mfma_f32_16x16x32_bf16 v[24:27], v[128:131], v[64:67], v[24:27]
    ds_read_b128 v[116:119], v35 offset:3072
    v_mfma_f32_16x16x32_bf16 v[28:31], v[128:131], v[68:71], v[28:31]
    ds_read_b128 v[120:123], v35 offset:3584
    v_mfma_f32_16x16x32_bf16 v[44:47], v[128:131], v[72:75], v[44:47]
    buffer_load_dwordx4 v12, s[12:15], s28 offen offset:1024 lds
    v_mfma_f32_16x16x32_bf16 v[48:51], v[128:131], v[76:79], v[48:51]
    ds_read2_b32 v[160:161], v39 offset0:0 offset1:1
    v_mfma_f32_16x16x32_bf16 v[52:55], v[128:131], v[80:83], v[52:55]
    ds_read2_b32 v[162:163], v39 offset0:2 offset1:3
    v_mfma_f32_16x16x32_bf16 v[56:59], v[128:131], v[84:87], v[56:59]
    ds_read2_b32 v[164:165], v38 offset0:128 offset1:129
    v_mfma_f32_16x16x32_bf16 v[24:27], v[132:135], v[60:63], v[24:27]
    ds_read2_b32 v[166:167], v38 offset0:130 offset1:131
    v_mfma_f32_16x16x32_bf16 v[28:31], v[132:135], v[64:67], v[28:31]
    ds_read2_b32 v[168:169], v38 offset0:0 offset1:1
    v_mfma_f32_16x16x32_bf16 v[44:47], v[132:135], v[68:71], v[44:47]
    buffer_load_dwordx4 v14, s[12:15], s28 offen offset:2048 lds
    v_mfma_f32_16x16x32_bf16 v[48:51], v[132:135], v[72:75], v[48:51]
    ds_read2_b32 v[170:171], v38 offset0:2 offset1:3
    v_mfma_f32_16x16x32_bf16 v[52:55], v[132:135], v[76:79], v[52:55]
    ds_read2_b32 v[172:173], v37 offset0:128 offset1:129
    v_mfma_f32_16x16x32_bf16 v[56:59], v[132:135], v[80:83], v[56:59]
    ds_read2_b32 v[174:175], v37 offset0:130 offset1:131
    v_mfma_f32_16x16x32_bf16 v[28:31], v[136:139], v[60:63], v[28:31]
    ds_read2_b32 v[176:177], v37 offset0:0 offset1:1
    v_mfma_f32_16x16x32_bf16 v[44:47], v[136:139], v[64:67], v[44:47]
    ds_read2_b32 v[178:179], v37 offset0:2 offset1:3
    v_mfma_f32_16x16x32_bf16 v[48:51], v[136:139], v[68:71], v[48:51]
    buffer_load_dwordx4 v15, s[12:15], s28 offen offset:3072 lds
    v_mfma_f32_16x16x32_bf16 v[52:55], v[136:139], v[72:75], v[52:55]
    ds_read2_b32 v[180:181], v36 offset0:128 offset1:129
    v_mfma_f32_16x16x32_bf16 v[56:59], v[136:139], v[76:79], v[56:59]
    ds_read2_b32 v[182:183], v36 offset0:130 offset1:131
    v_mfma_f32_16x16x32_bf16 v[44:47], v[140:143], v[60:63], v[44:47]
    ds_read2_b32 v[184:185], v36 offset0:0 offset1:1
    v_mfma_f32_16x16x32_bf16 v[48:51], v[140:143], v[64:67], v[48:51]
    ds_read2_b32 v[186:187], v36 offset0:2 offset1:3
    v_mfma_f32_16x16x32_bf16 v[52:55], v[140:143], v[68:71], v[52:55]
    v_mfma_f32_16x16x32_bf16 v[56:59], v[140:143], v[72:75], v[56:59]
    s_add_u32 m0, s24, 61440
    s_nop 0
    buffer_load_dwordx4 v32, s[12:15], s28 offen offset:0 lds
    v_mfma_f32_16x16x32_bf16 v[48:51], v[144:147], v[60:63], v[48:51]
    v_mfma_f32_16x16x32_bf16 v[52:55], v[144:147], v[64:67], v[52:55]
    v_mfma_f32_16x16x32_bf16 v[56:59], v[144:147], v[68:71], v[56:59]
    v_mfma_f32_16x16x32_bf16 v[52:55], v[148:151], v[60:63], v[52:55]
    v_mfma_f32_16x16x32_bf16 v[56:59], v[148:151], v[64:67], v[56:59]
    v_mfma_f32_16x16x32_bf16 v[56:59], v[152:155], v[60:63], v[56:59]
    buffer_load_dwordx4 v33, s[12:15], s28 offen offset:1024 lds
    s_waitcnt lgkmcnt(0)
    v_mfma_f32_16x16x32_bf16 v[16:19], v[156:159], v[92:95], v[16:19]
    ds_read_b64 v[76:77], v42 offset:512
    v_mfma_f32_16x16x32_bf16 v[20:23], v[156:159], v[96:99], v[20:23]
    ds_read_b64 v[84:85], v42 offset:4608
    v_mfma_f32_16x16x32_bf16 v[24:27], v[156:159], v[100:103], v[24:27]
    ds_read_b64 v[78:79], v42 offset:1024
    v_mfma_f32_16x16x32_bf16 v[28:31], v[156:159], v[104:107], v[28:31]
    ds_read_b64 v[86:87], v42 offset:5120
    v_mfma_f32_16x16x32_bf16 v[44:47], v[156:159], v[108:111], v[44:47]
    ds_read_b64 v[80:81], v42 offset:1536
    v_mfma_f32_16x16x32_bf16 v[48:51], v[156:159], v[112:115], v[48:51]
    buffer_load_dwordx4 v34, s[12:15], s28 offen offset:2048 lds
    v_mfma_f32_16x16x32_bf16 v[52:55], v[156:159], v[116:119], v[52:55]
    ds_read_b64 v[88:89], v42 offset:5632
    v_mfma_f32_16x16x32_bf16 v[56:59], v[156:159], v[120:123], v[56:59]
    ds_read_b64 v[82:83], v42 offset:2048
    v_mfma_f32_16x16x32_bf16 v[20:23], v[160:163], v[92:95], v[20:23]
    ds_read_b64 v[90:91], v42 offset:6144
    v_mfma_f32_16x16x32_bf16 v[24:27], v[160:163], v[96:99], v[24:27]
    s_waitcnt lgkmcnt(0)
    v_mfma_f32_16x16x32_bf16 v[28:31], v[160:163], v[100:103], v[28:31]
    v_lshlrev_b32 v140, 16, v76
    v_mfma_f32_16x16x32_bf16 v[44:47], v[160:163], v[104:107], v[44:47]
    s_add_u32 m0, s24, 86016
    s_add_u32 s28, s25, 1376256
    buffer_load_dwordx4 v11, s[12:15], s28 offen offset:0 lds
    v_mfma_f32_16x16x32_bf16 v[48:51], v[160:163], v[108:111], v[48:51]
    v_and_b32 v141, s26, v76
    v_mfma_f32_16x16x32_bf16 v[52:55], v[160:163], v[112:115], v[52:55]
    v_lshlrev_b32 v124, 16, v84
    v_mfma_f32_16x16x32_bf16 v[56:59], v[160:163], v[116:119], v[56:59]
    v_and_b32 v125, s26, v84
    v_mfma_f32_16x16x32_bf16 v[24:27], v[164:167], v[92:95], v[24:27]
    v_fmac_f32 v124, s3, v140
    v_mfma_f32_16x16x32_bf16 v[28:31], v[164:167], v[96:99], v[28:31]
    v_fmac_f32 v125, s3, v141
    v_mfma_f32_16x16x32_bf16 v[44:47], v[164:167], v[100:103], v[44:47]
    buffer_load_dwordx4 v12, s[12:15], s28 offen offset:1024 lds
    v_mfma_f32_16x16x32_bf16 v[48:51], v[164:167], v[104:107], v[48:51]
    v_lshlrev_b32 v142, 16, v77
    v_mfma_f32_16x16x32_bf16 v[52:55], v[164:167], v[108:111], v[52:55]
    v_and_b32 v143, s26, v77
    v_mfma_f32_16x16x32_bf16 v[56:59], v[164:167], v[112:115], v[56:59]
    v_lshlrev_b32 v126, 16, v85
    v_mfma_f32_16x16x32_bf16 v[28:31], v[168:171], v[92:95], v[28:31]
    v_and_b32 v127, s26, v85
    v_mfma_f32_16x16x32_bf16 v[44:47], v[168:171], v[96:99], v[44:47]
    v_fmac_f32 v126, s3, v142
    v_mfma_f32_16x16x32_bf16 v[48:51], v[168:171], v[100:103], v[48:51]
    buffer_load_dwordx4 v14, s[12:15], s28 offen offset:2048 lds
    v_mfma_f32_16x16x32_bf16 v[52:55], v[168:171], v[104:107], v[52:55]
    v_fmac_f32 v127, s3, v143
    v_mfma_f32_16x16x32_bf16 v[56:59], v[168:171], v[108:111], v[56:59]
    v_lshlrev_b32 v140, 16, v78
    v_mfma_f32_16x16x32_bf16 v[44:47], v[172:175], v[92:95], v[44:47]
    v_and_b32 v141, s26, v78
    v_mfma_f32_16x16x32_bf16 v[48:51], v[172:175], v[96:99], v[48:51]
    v_lshlrev_b32 v128, 16, v86
    v_mfma_f32_16x16x32_bf16 v[52:55], v[172:175], v[100:103], v[52:55]
    v_and_b32 v129, s26, v86
    v_mfma_f32_16x16x32_bf16 v[56:59], v[172:175], v[104:107], v[56:59]
    buffer_load_dwordx4 v15, s[12:15], s28 offen offset:3072 lds
    v_mfma_f32_16x16x32_bf16 v[48:51], v[176:179], v[92:95], v[48:51]
    v_fmac_f32 v128, s3, v140
    v_mfma_f32_16x16x32_bf16 v[52:55], v[176:179], v[96:99], v[52:55]
    v_fmac_f32 v129, s3, v141
    v_mfma_f32_16x16x32_bf16 v[56:59], v[176:179], v[100:103], v[56:59]
    v_lshlrev_b32 v142, 16, v79
    v_mfma_f32_16x16x32_bf16 v[52:55], v[180:183], v[92:95], v[52:55]
    v_and_b32 v143, s26, v79
    v_mfma_f32_16x16x32_bf16 v[56:59], v[180:183], v[96:99], v[56:59]
    v_lshlrev_b32 v130, 16, v87
    v_mfma_f32_16x16x32_bf16 v[56:59], v[184:187], v[92:95], v[56:59]
    s_add_u32 m0, s24, 90112
    s_nop 0
    buffer_load_dwordx4 v32, s[12:15], s28 offen offset:0 lds
    s_waitcnt lgkmcnt(0)
    s_barrier
    s_cmp_eq_u32 s23, 0
    s_cbranch_scc0 sequential_preLN__ssm_conv_s4d__dense_activation_gelu__prompt_kernel_snd112
    ds_write_b128 v40, v[44:47] offset:0
    ds_write_b128 v40, v[48:51] offset:1024
    ds_write_b128 v40, v[52:55] offset:2048
    ds_write_b128 v40, v[56:59] offset:3072
    s_branch sequential_preLN__ssm_conv_s4d__dense_activation_gelu__prompt_kernel_sndx13
sequential_preLN__ssm_conv_s4d__dense_activation_gelu__prompt_kernel_snd112:
    ds_write_b128 v40, v[16:19] offset:0
    ds_write_b128 v40, v[20:23] offset:1024
    ds_write_b128 v40, v[24:27] offset:2048
    ds_write_b128 v40, v[28:31] offset:3072
sequential_preLN__ssm_conv_s4d__dense_activation_gelu__prompt_kernel_sndx13:
    buffer_load_dwordx4 v33, s[12:15], s28 offen offset:1024 lds
    buffer_load_dwordx4 v34, s[12:15], s28 offen offset:2048 lds
    v_and_b32 v131, s26, v87
    v_fmac_f32 v130, s3, v142
    v_fmac_f32 v131, s3, v143
    v_lshlrev_b32 v140, 16, v80
    v_and_b32 v141, s26, v80
    v_lshlrev_b32 v132, 16, v88
    v_and_b32 v133, s26, v88
    v_fmac_f32 v132, s3, v140
    v_fmac_f32 v133, s3, v141
    v_lshlrev_b32 v142, 16, v81
    v_and_b32 v143, s26, v81
    v_lshlrev_b32 v134, 16, v89
    v_and_b32 v135, s26, v89
    v_fmac_f32 v134, s3, v142
    v_fmac_f32 v135, s3, v143
    v_lshlrev_b32 v140, 16, v82
    v_and_b32 v141, s26, v82
    v_lshlrev_b32 v136, 16, v90
    v_and_b32 v137, s26, v90
    v_fmac_f32 v136, s3, v140
    v_fmac_f32 v137, s3, v141
    v_lshlrev_b32 v142, 16, v83
    v_and_b32 v143, s26, v83
    v_lshlrev_b32 v138, 16, v91
    v_and_b32 v139, s26, v91
    v_fmac_f32 v138, s3, v142
    v_fmac_f32 v139, s3, v143
    s_waitcnt lgkmcnt(0)
    s_barrier
    s_cmp_eq_u32 s23, 0
    s_cbranch_scc0 sequential_preLN__ssm_conv_s4d__dense_activation_gelu__prompt_kernel_epi114
    ds_read_b128 v[60:63], v41 offset:0
    ds_read_b128 v[64:67], v41 offset:1024
    ds_read_b128 v[68:71], v41 offset:2048
    ds_read_b128 v[72:75], v41 offset:3072
    v_pk_add_f32 v[16:17], v[16:17], v[124:125]
    v_pk_add_f32 v[18:19], v[18:19], v[126:127]
    v_pk_add_f32 v[20:21], v[20:21], v[128:129]
    v_pk_add_f32 v[22:23], v[22:23], v[130:131]
    v_pk_add_f32 v[24:25], v[24:25], v[132:133]
    v_pk_add_f32 v[26:27], v[26:27], v[134:135]
    v_pk_add_f32 v[28:29], v[28:29], v[136:137]
    v_pk_add_f32 v[30:31], v[30:31], v[138:139]
    s_waitcnt lgkmcnt(3)
    v_pk_add_f32 v[16:17], v[16:17], v[60:61]
    v_pk_add_f32 v[18:19], v[18:19], v[62:63]
    v_cvt_pk_bf16_f32 v144, v16, v17
    v_cvt_pk_bf16_f32 v145, v18, v19
    s_add_u32 s27, s31, 0
    buffer_store_dwordx2 v[144:145], v43, s[8:11], s27 offen sc1
    s_waitcnt lgkmcnt(2)
    v_pk_add_f32 v[20:21], v[20:21], v[64:65]
    v_pk_add_f32 v[22:23], v[22:23], v[66:67]
    v_cvt_pk_bf16_f32 v146, v20, v21
    v_cvt_pk_bf16_f32 v147, v22, v23
    s_add_u32 s27, s31, 262144
    buffer_store_dwordx2 v[146:147], v43, s[8:11], s27 offen sc1
    s_waitcnt lgkmcnt(1)
    v_pk_add_f32 v[24:25], v[24:25], v[68:69]
    v_pk_add_f32 v[26:27], v[26:27], v[70:71]
    v_cvt_pk_bf16_f32 v148, v24, v25
    v_cvt_pk_bf16_f32 v149, v26, v27
    s_add_u32 s27, s31, 524288
    buffer_store_dwordx2 v[148:149], v43, s[8:11], s27 offen sc1
    s_waitcnt lgkmcnt(0)
    v_pk_add_f32 v[28:29], v[28:29], v[72:73]
    v_pk_add_f32 v[30:31], v[30:31], v[74:75]
    v_cvt_pk_bf16_f32 v150, v28, v29
    v_cvt_pk_bf16_f32 v151, v30, v31
    s_add_u32 s27, s31, 786432
    buffer_store_dwordx2 v[150:151], v43, s[8:11], s27 offen sc1
    s_branch sequential_preLN__ssm_conv_s4d__dense_activation_gelu__prompt_kernel_epid15
sequential_preLN__ssm_conv_s4d__dense_activation_gelu__prompt_kernel_epi114:
    ds_read_b128 v[60:63], v41 offset:0
    ds_read_b128 v[64:67], v41 offset:1024
    ds_read_b128 v[68:71], v41 offset:2048
    ds_read_b128 v[72:75], v41 offset:3072
    v_pk_add_f32 v[44:45], v[44:45], v[124:125]
    v_pk_add_f32 v[46:47], v[46:47], v[126:127]
    v_pk_add_f32 v[48:49], v[48:49], v[128:129]
    v_pk_add_f32 v[50:51], v[50:51], v[130:131]
    v_pk_add_f32 v[52:53], v[52:53], v[132:133]
    v_pk_add_f32 v[54:55], v[54:55], v[134:135]
    v_pk_add_f32 v[56:57], v[56:57], v[136:137]
    v_pk_add_f32 v[58:59], v[58:59], v[138:139]
    s_waitcnt lgkmcnt(3)
    v_pk_add_f32 v[44:45], v[44:45], v[60:61]
    v_pk_add_f32 v[46:47], v[46:47], v[62:63]
    v_cvt_pk_bf16_f32 v144, v44, v45
    v_cvt_pk_bf16_f32 v145, v46, v47
    s_add_u32 s27, s31, 0
    buffer_store_dwordx2 v[144:145], v43, s[8:11], s27 offen sc1
    s_waitcnt lgkmcnt(2)
    v_pk_add_f32 v[48:49], v[48:49], v[64:65]
    v_pk_add_f32 v[50:51], v[50:51], v[66:67]
    v_cvt_pk_bf16_f32 v146, v48, v49
    v_cvt_pk_bf16_f32 v147, v50, v51
    s_add_u32 s27, s31, 262144
    buffer_store_dwordx2 v[146:147], v43, s[8:11], s27 offen sc1
    s_waitcnt lgkmcnt(1)
    v_pk_add_f32 v[52:53], v[52:53], v[68:69]
    v_pk_add_f32 v[54:55], v[54:55], v[70:71]
    v_cvt_pk_bf16_f32 v148, v52, v53
    v_cvt_pk_bf16_f32 v149, v54, v55
    s_add_u32 s27, s31, 524288
    buffer_store_dwordx2 v[148:149], v43, s[8:11], s27 offen sc1
    s_waitcnt lgkmcnt(0)
    v_pk_add_f32 v[56:57], v[56:57], v[72:73]
    v_pk_add_f32 v[58:59], v[58:59], v[74:75]
    v_cvt_pk_bf16_f32 v150, v56, v57
    v_cvt_pk_bf16_f32 v151, v58, v59
    s_add_u32 s27, s31, 786432
    buffer_store_dwordx2 v[150:151], v43, s[8:11], s27 offen sc1
sequential_preLN__ssm_conv_s4d__dense_activation_gelu__prompt_kernel_epid15:
    s_mov_b32 s16, s54
    s_mov_b32 s17, s55
    s_mov_b32 s18, 0xe00
    s_mov_b32 s19, 0x00020000
    v_lshrrev_b32 v6, 4, v1
    v_lshlrev_b32 v10, 3, v6
    s_mul_i32 s26, s67, 224
    buffer_load_dwordx2 v[42:43], v10, s[16:19], s26 offen offset:0
    buffer_load_dwordx2 v[46:47], v10, s[16:19], s26 offen offset:32
    buffer_load_dwordx2 v[50:51], v10, s[16:19], s26 offen offset:64
    buffer_load_dwordx2 v[54:55], v10, s[16:19], s26 offen offset:96
    buffer_load_dwordx2 v[58:59], v10, s[16:19], s26 offen offset:128
    buffer_load_dwordx2 v[62:63], v10, s[16:19], s26 offen offset:160
    buffer_load_dwordx2 v[66:67], v10, s[16:19], s26 offen offset:192
    s_getpc_b64 s[28:29]
sequential_preLN__ssm_conv_s4d__dense_activation_gelu__prompt_kernel_pc17:
    s_lshr_b32 s24, s2, 3
    s_lshl_b32 s24, s24, 10
    v_add_u32 v11, s24, v2
    s_mov_b32 s24, sequential_preLN__ssm_conv_s4d__dense_activation_gelu__prompt_kernel_codeend-sequential_preLN__ssm_conv_s4d__dense_activation_gelu__prompt_kernel_pc17-16
    v_min_u32 v11, s24, v11
    global_load_dwordx4 v[68:71], v11, s[28:29]
    v_lshrrev_b32 v6, 2, v1
    v_and_b32 v7, 7, v6
    v_and_b32 v9, 3, v1
    v_lshlrev_b32 v9, 3, v9
    v_mul_u32_u24 v81, 224, v6
    v_add_u32 v81, v81, v9
    v_mov_b32 v79, v81
    v_add_u32 v80, 57344, v79
    s_mov_b32 s26, 0x3f803f80
    v_mov_b32 v156, s26
    buffer_load_dwordx4 a[0:3], v5, s[8:11], s34 offen offset:0 sc1
    v_mov_b32 v157, s26
    v_mov_b32 v158, s26
    v_mov_b32 v159, s26
    s_add_u32 s27, s20, 4
    s_min_u32 s27, s27, 6
    s_lshl_b32 s26, s20, 5
    v_add_u32 v82, s26, v81
    v_add_u32 v83, 57344, v82
    s_lshl_b32 s26, s27, 5
    v_add_u32 v232, s26, v81
    buffer_load_dwordx4 a[4:7], v5, s[8:11], s34 offen offset:1024 sc1
    v_add_u32 v233, 57344, v232
    s_lshl_b32 s26, s20, 10
    s_add_u32 s26, s26, 114688
    v_add_u32 v76, s26, v2
    s_lshl_b32 s26, s27, 10
    s_add_u32 s26, s26, 114688
    v_add_u32 v77, s26, v2
    v_and_b32 v78, 48, v1
    v_lshlrev_b32 v78, 4, v78
    v_add_u32 v78, 114688, v78
    s_mov_b32 s16, s58
    s_mov_b32 s17, s59
    s_mov_b32 s18, 0x400
    s_mov_b32 s19, 0x00020000
    s_lshl_b32 s47, s70, 7
    buffer_load_dwordx2 v[236:237], v10, s[16:19], s47 offen offset:0
    buffer_load_dwordx2 v[238:239], v10, s[16:19], s47 offen offset:32
    buffer_load_dwordx2 v[240:241], v10, s[16:19], s47 offen offset:64
    buffer_load_dwordx2 v[242:243], v10, s[16:19], s47 offen offset:96
    s_waitcnt vmcnt(14)
    s_barrier
    s_cmp_eq_u32 s20, 1
    s_cbranch_scc0 sequential_preLN__ssm_conv_s4d__dense_activation_gelu__prompt_kernel_nw18
    v_mov_b32 v6, s51
    s_mov_b32 s7, 32768
    s_mov_b64 exec, 0xff
    buffer_store_dword v6, v3, s[8:11], s7 offen sc1
    s_mov_b64 exec, -1
sequential_preLN__ssm_conv_s4d__dense_activation_gelu__prompt_kernel_nw18:
    ds_read_b64_tr_b16 v[176:177], v82 offset:0
    v_lshrrev_b32 v6, 4, v1
    ds_read_b64_tr_b16 v[178:179], v82 offset:3584
    v_add_u32 v7, 0, v6
    ds_read_b64_tr_b16 v[180:181], v232 offset:0
    v_bfe_u32 v8, v1, 1, 3
    ds_read_b64_tr_b16 v[182:183], v232 offset:3584
    v_xor_b32 v7, v7, v8
    ds_read_b64_tr_b16 v[184:185], v82 offset:7168
    v_lshlrev_b32 v7, 5, v7
    ds_read_b64_tr_b16 v[186:187], v82 offset:10752
    v_lshl_add_u32 v7, v6, 8, v7
    ds_read_b64_tr_b16 v[188:189], v232 offset:7168
    v_and_b32 v8, 1, v1
    ds_read_b64_tr_b16 v[190:191], v232 offset:10752
    v_lshl_add_u32 v72, v8, 4, v7
    s_waitcnt lgkmcnt(0)
    v_lshrrev_b32 v6, 4, v1
    ds_read_b64_tr_b16 v[204:205], v82 offset:14336
    v_add_u32 v7, 4, v6
    ds_read_b64_tr_b16 v[206:207], v82 offset:17920
    v_bfe_u32 v8, v1, 1, 3
    ds_read_b64_tr_b16 v[208:209], v232 offset:14336
    v_xor_b32 v7, v7, v8
    ds_read_b64_tr_b16 v[210:211], v232 offset:17920
    v_lshlrev_b32 v7, 5, v7
    ds_read_b64_tr_b16 v[212:213], v82 offset:21504
    v_lshl_add_u32 v7, v6, 8, v7
    ds_read_b64_tr_b16 v[214:215], v82 offset:25088
    v_and_b32 v8, 1, v1
    ds_read_b64_tr_b16 v[216:217], v232 offset:21504
    v_lshl_add_u32 v73, v8, 4, v7
    ds_read_b64_tr_b16 v[218:219], v232 offset:25088
    s_lshl_b32 s24, s66, 17
    v_mfma_f32_16x16x32_bf16 v[12:15], v[176:179], v[156:159], 0
    s_lshl_b32 s25, s20, 12
    v_mfma_f32_16x16x32_bf16 v[16:19], v[180:183], v[156:159], 0
    s_add_u32 s24, s24, s25
    buffer_load_dwordx4 a[8:11], v5, s[8:11], s34 offen offset:2048 sc1
    s_add_u32 s24, s24, 8388608
    v_mfma_f32_16x16x32_bf16 v[12:15], v[184:187], v[156:159], v[12:15]
    s_add_u32 s25, s25, 114688
    v_mfma_f32_16x16x32_bf16 v[16:19], v[188:191], v[156:159], v[16:19]
    v_lshrrev_b32 v6, 2, v1
    buffer_load_dwordx4 a[12:15], v5, s[8:11], s34 offen offset:3072 sc1
    v_and_b32 v7, 7, v6
    s_waitcnt lgkmcnt(0)
    v_and_b32 v9, 3, v1
    ds_read_b64_tr_b16 v[176:177], v82 offset:28672
    v_lshlrev_b32 v9, 3, v9
    ds_read_b64_tr_b16 v[178:179], v82 offset:32256
    s_lshl_b32 s26, s20, 1
    ds_read_b64_tr_b16 v[180:181], v232 offset:28672
    s_add_u32 s27, s26, 0
    ds_read_b64_tr_b16 v[182:183], v232 offset:32256
    v_xor_b32 v8, s27, v7
    ds_read_b64_tr_b16 v[184:185], v82 offset:35840
    v_lshlrev_b32 v8, 5, v8
    ds_read_b64_tr_b16 v[186:187], v82 offset:39424
    v_lshl_add_u32 v8, v6, 8, v8
    ds_read_b64_tr_b16 v[188:189], v232 offset:35840
    v_add_u32 v8, v8, v9
    ds_read_b64_tr_b16 v[190:191], v232 offset:39424
    v_add_u32 v74, 114688, v8
    v_mfma_f32_16x16x32_bf16 v[12:15], v[204:207], v[156:159], v[12:15]
    s_add_u32 s27, s26, 1
    v_mfma_f32_16x16x32_bf16 v[16:19], v[208:211], v[156:159], v[16:19]
    v_xor_b32 v8, s27, v7
    v_add_u32 v5, 4096, v5
    v_lshlrev_b32 v8, 5, v8
    buffer_load_dwordx4 a[16:19], v5, s[8:11], s34 offen offset:0 sc1
    v_lshl_add_u32 v8, v6, 8, v8
    v_mfma_f32_16x16x32_bf16 v[12:15], v[212:215], v[156:159], v[12:15]
    v_add_u32 v8, v8, v9
    v_mfma_f32_16x16x32_bf16 v[16:19], v[216:219], v[156:159], v[16:19]
    v_add_u32 v75, 114688, v8
    buffer_load_dwordx4 a[20:23], v5, s[8:11], s34 offen offset:1024 sc1
    v_lshrrev_b32 v6, 1, v1
    s_waitcnt lgkmcnt(0)
    v_lshlrev_b32 v234, 8, v6
    ds_read_b64_tr_b16 v[204:205], v82 offset:43008
    v_and_b32 v7, 1, v1
    ds_read_b64_tr_b16 v[206:207], v82 offset:46592
    v_lshl_add_u32 v234, v7, 4, v234
    ds_read_b64_tr_b16 v[208:209], v232 offset:43008
    s_lshr_b32 s4, s69, 1
    ds_read_b64_tr_b16 v[210:211], v232 offset:46592
    s_lshl_b32 s4, s4, 17
    ds_read_b64_tr_b16 v[212:213], v82 offset:50176
    s_lshl_b32 s5, s70, 14
    ds_read_b64_tr_b16 v[214:215], v82 offset:53760
    s_add_u32 s4, s4, s5
    ds_read_b64_tr_b16 v[216:217], v232 offset:50176
    s_and_b32 s5, s69, 1
    ds_read_b64_tr_b16 v[218:219], v232 offset:53760
    s_lshl_b32 s5, s5, 7
    v_mfma_f32_16x16x32_bf16 v[12:15], v[176:179], v[156:159], v[12:15]
    s_add_u32 s4, s4, s5
    v_mfma_f32_16x16x32_bf16 v[16:19], v[180:183], v[156:159], v[16:19]
    s_lshl_b32 s5, s20, 5
    buffer_load_dwordx4 a[24:27], v5, s[8:11], s34 offen offset:2048 sc1
    s_add_u32 s4, s4, s5
    v_mfma_f32_16x16x32_bf16 v[12:15], v[184:187], v[156:159], v[12:15]
    s_add_u32 s4, s4, 8388608
    v_mfma_f32_16x16x32_bf16 v[16:19], v[188:191], v[156:159], v[16:19]
    s_lshl_b32 s5, s20, 11
    buffer_load_dwordx4 a[28:31], v5, s[8:11], s34 offen offset:3072 sc1
    s_add_u32 s5, s5, 147456
    s_waitcnt lgkmcnt(0)
    v_and_b32 v6, 15, v1
    ds_read_b64_tr_b16 v[176:177], v83 offset:0
    v_lshrrev_b32 v7, 2, v6
    ds_read_b64_tr_b16 v[178:179], v83 offset:3584
    v_lshl_add_u32 v244, v7, 4, v6
    ds_read_b64_tr_b16 v[180:181], v233 offset:0
    v_lshlrev_b32 v244, 2, v244
    ds_read_b64_tr_b16 v[182:183], v233 offset:3584
    v_and_b32 v235, 3, v6
    ds_read_b64_tr_b16 v[184:185], v83 offset:7168
    v_lshlrev_b32 v245, 3, v1
    ds_read_b64_tr_b16 v[186:187], v83 offset:10752
    s_mov_b32 s28, 0xbdd2d3e8
    ds_read_b64_tr_b16 v[188:189], v233 offset:7168
    s_mov_b32 s29, 0xbdd2d3e8
    ds_read_b64_tr_b16 v[190:191], v233 offset:10752
    s_lshr_b32 s27, s20, 1
    v_mfma_f32_16x16x32_bf16 v[12:15], v[204:207], v[156:159], v[12:15]
    s_lshl_b32 s30, s66, 1
    v_mfma_f32_16x16x32_bf16 v[16:19], v[208:211], v[156:159], v[16:19]
    s_add_u32 s30, s30, s27
    v_add_u32 v5, 4096, v5
    s_lshl_b32 s30, s30, 18
    buffer_load_dwordx4 a[32:35], v5, s[8:11], s34 offen offset:0 sc1
    s_and_b32 s27, s20, 1
    v_mfma_f32_16x16x32_bf16 v[12:15], v[212:215], v[156:159], v[12:15]
    s_lshl_b32 s27, s27, 11
    v_mfma_f32_16x16x32_bf16 v[16:19], v[216:219], v[156:159], v[16:19]
    s_add_u32 s30, s30, s27
    buffer_load_dwordx4 a[36:39], v5, s[8:11], s34 offen offset:1024 sc1
    s_add_u32 s30, s30, 10485760
    s_waitcnt lgkmcnt(0)
    s_lshl_b32 s27, s67, 14
    ds_read_b64_tr_b16 v[204:205], v83 offset:14336
    s_add_u32 s30, s30, s27
    ds_read_b64_tr_b16 v[206:207], v83 offset:17920
    s_lshl_b32 s38, s69, 18
    ds_read_b64_tr_b16 v[208:209], v233 offset:14336
    s_lshl_b32 s26, s20, 16
    ds_read_b64_tr_b16 v[210:211], v233 offset:17920
    s_add_u32 s38, s38, s26
    ds_read_b64_tr_b16 v[212:213], v83 offset:21504
    s_add_u32 s38, s38, 10485760
    ds_read_b64_tr_b16 v[214:215], v83 offset:25088
    s_add_u32 s26, s20, 0
    ds_read_b64_tr_b16 v[216:217], v233 offset:21504
    s_and_b32 s26, s26, 3
    ds_read_b64_tr_b16 v[218:219], v233 offset:25088
    s_lshl_b32 s42, s26, 10
    v_mfma_f32_16x16x32_bf16 v[12:15], v[176:179], v[156:159], v[12:15]
    v_add_u32 v246, s42, v2
    v_mfma_f32_16x16x32_bf16 v[16:19], v[180:183], v[156:159], v[16:19]
    s_add_u32 s26, s20, 1
    buffer_load_dwordx4 a[40:43], v5, s[8:11], s34 offen offset:2048 sc1
    s_and_b32 s26, s26, 3
    v_mfma_f32_16x16x32_bf16 v[12:15], v[184:187], v[156:159], v[12:15]
    s_lshl_b32 s43, s26, 10
    v_mfma_f32_16x16x32_bf16 v[16:19], v[188:191], v[156:159], v[16:19]
    v_add_u32 v247, s43, v2
    buffer_load_dwordx4 a[44:47], v5, s[8:11], s34 offen offset:3072 sc1
    s_add_u32 s26, s20, 2
    s_waitcnt lgkmcnt(0)
    s_and_b32 s26, s26, 3
    ds_read_b64_tr_b16 v[176:177], v83 offset:28672
    s_lshl_b32 s44, s26, 10
    ds_read_b64_tr_b16 v[178:179], v83 offset:32256
    v_add_u32 v248, s44, v2
    ds_read_b64_tr_b16 v[180:181], v233 offset:28672
    s_add_u32 s26, s20, 3
    ds_read_b64_tr_b16 v[182:183], v233 offset:32256
    s_and_b32 s26, s26, 3
    ds_read_b64_tr_b16 v[184:185], v83 offset:35840
    s_lshl_b32 s45, s26, 10
    ds_read_b64_tr_b16 v[186:187], v83 offset:39424
    v_add_u32 v249, s45, v2
    ds_read_b64_tr_b16 v[188:189], v233 offset:35840
    s_mov_b32 s40, 0
    ds_read_b64_tr_b16 v[190:191], v233 offset:39424
    v_mfma_f32_16x16x32_bf16 v[12:15], v[204:207], v[156:159], v[12:15]
    v_mfma_f32_16x16x32_bf16 v[16:19], v[208:211], v[156:159], v[16:19]
    v_add_u32 v5, 4096, v5
    buffer_load_dwordx4 a[48:51], v5, s[8:11], s34 offen offset:0 sc1
    v_mfma_f32_16x16x32_bf16 v[12:15], v[212:215], v[156:159], v[12:15]
    v_mfma_f32_16x16x32_bf16 v[16:19], v[216:219], v[156:159], v[16:19]
    buffer_load_dwordx4 a[52:55], v5, s[8:11], s34 offen offset:1024 sc1
    s_waitcnt lgkmcnt(0)
    ds_read_b64_tr_b16 v[204:205], v83 offset:43008
    ds_read_b64_tr_b16 v[206:207], v83 offset:46592
    ds_read_b64_tr_b16 v[208:209], v233 offset:43008
    ds_read_b64_tr_b16 v[210:211], v233 offset:46592
    ds_read_b64_tr_b16 v[212:213], v83 offset:50176
    ds_read_b64_tr_b16 v[214:215], v83 offset:53760
    ds_read_b64_tr_b16 v[216:217], v233 offset:50176
    ds_read_b64_tr_b16 v[218:219], v233 offset:53760
    v_mfma_f32_16x16x32_bf16 v[12:15], v[176:179], v[156:159], v[12:15]
    v_mfma_f32_16x16x32_bf16 v[16:19], v[180:183], v[156:159], v[16:19]
    buffer_load_dwordx4 a[56:59], v5, s[8:11], s34 offen offset:2048 sc1
    v_mfma_f32_16x16x32_bf16 v[12:15], v[184:187], v[156:159], v[12:15]
    v_mfma_f32_16x16x32_bf16 v[16:19], v[188:191], v[156:159], v[16:19]
    buffer_load_dwordx4 a[60:63], v5, s[8:11], s34 offen offset:3072 sc1
    s_waitcnt lgkmcnt(0)
    v_mfma_f32_16x16x32_bf16 v[12:15], v[204:207], v[156:159], v[12:15]
    v_mfma_f32_16x16x32_bf16 v[16:19], v[208:211], v[156:159], v[16:19]
    v_add_u32 v5, 4096, v5
    buffer_load_dwordx4 a[64:67], v5, s[8:11], s34 offen offset:0 sc1
    v_mfma_f32_16x16x32_bf16 v[12:15], v[212:215], v[156:159], v[12:15]
    v_mfma_f32_16x16x32_bf16 v[16:19], v[216:219], v[156:159], v[16:19]
    buffer_load_dwordx4 a[68:71], v5, s[8:11], s34 offen offset:1024 sc1
    s_nop 5
    ds_write_b128 v76, v[12:15]
    ds_write_b128 v77, v[16:19]
    s_waitcnt lgkmcnt(0)
    s_barrier
    ds_read_b128 v[12:15], v78 offset:0
    ds_read_b128 v[16:19], v78 offset:1024
    ds_read_b128 v[20:23], v78 offset:2048
    ds_read_b128 v[24:27], v78 offset:3072
    ds_read_b128 v[28:31], v78 offset:4096
    ds_read_b128 v[32:35], v78 offset:5120
    ds_read_b128 v[36:39], v78 offset:6144
    ds_read_b64_tr_b16 v[176:177], v79 offset:0
    ds_read_b64_tr_b16 v[178:179], v79 offset:3584
    ds_read_b64_tr_b16 v[180:181], v79 offset:32
    ds_read_b64_tr_b16 v[182:183], v79 offset:3616
    ds_read_b64_tr_b16 v[184:185], v79 offset:64
    ds_read_b64_tr_b16 v[186:187], v79 offset:3648
    ds_read_b64_tr_b16 v[188:189], v79 offset:96
    ds_read_b64_tr_b16 v[190:191], v79 offset:3680
    ds_read_b64_tr_b16 v[192:193], v79 offset:128
    ds_read_b64_tr_b16 v[194:195], v79 offset:3712
    ds_read_b64_tr_b16 v[196:197], v79 offset:160
    ds_read_b64_tr_b16 v[198:199], v79 offset:3744
    ds_read_b64_tr_b16 v[200:201], v79 offset:192
    ds_read_b64_tr_b16 v[202:203], v79 offset:3776
    s_cmp_eq_u32 s20, 0
    s_cbranch_scc0 sequential_preLN__ssm_conv_s4d__dense_activation_gelu__prompt_kernel_nw19
    s_mov_b32 s7, 32768
    buffer_load_dwordx4 v[68:71], v4, s[8:11], s7 offen sc1
sequential_preLN__ssm_conv_s4d__dense_activation_gelu__prompt_kernel_nw19:
    s_waitcnt vmcnt(23)
    v_lshlrev_b32 v40, 16, v42
    v_and_b32 v41, 0xffff0000, v42
    v_lshlrev_b32 v42, 16, v43
    v_and_b32 v43, 0xffff0000, v43
    buffer_load_dwordx4 a[72:75], v5, s[8:11], s34 offen offset:2048 sc1
    v_lshlrev_b32 v44, 16, v46
    v_and_b32 v45, 0xffff0000, v46
    v_lshlrev_b32 v46, 16, v47
    v_and_b32 v47, 0xffff0000, v47
    buffer_load_dwordx4 a[76:79], v5, s[8:11], s34 offen offset:3072 sc1
    v_lshlrev_b32 v48, 16, v50
    v_and_b32 v49, 0xffff0000, v50
    v_lshlrev_b32 v50, 16, v51
    v_and_b32 v51, 0xffff0000, v51
    v_add_u32 v5, 4096, v5
    buffer_load_dwordx4 a[80:83], v5, s[8:11], s34 offen offset:0 sc1
    v_lshlrev_b32 v52, 16, v54
    v_and_b32 v53, 0xffff0000, v54
    v_lshlrev_b32 v54, 16, v55
    v_and_b32 v55, 0xffff0000, v55
    buffer_load_dwordx4 a[84:87], v5, s[8:11], s34 offen offset:1024 sc1
    v_lshlrev_b32 v56, 16, v58
    v_and_b32 v57, 0xffff0000, v58
    v_lshlrev_b32 v58, 16, v59
    v_and_b32 v59, 0xffff0000, v59
    buffer_load_dwordx4 a[88:91], v5, s[8:11], s34 offen offset:2048 sc1
    v_lshlrev_b32 v60, 16, v62
    v_and_b32 v61, 0xffff0000, v62
    v_lshlrev_b32 v62, 16, v63
    v_and_b32 v63, 0xffff0000, v63
    buffer_load_dwordx4 a[92:95], v5, s[8:11], s34 offen offset:3072 sc1
    v_lshlrev_b32 v64, 16, v66
    v_and_b32 v65, 0xffff0000, v66
    v_lshlrev_b32 v66, 16, v67
    v_and_b32 v67, 0xffff0000, v67
    s_cmp_eq_u32 s20, 0
    s_cbranch_scc0 sequential_preLN__ssm_conv_s4d__dense_activation_gelu__prompt_kernel_nw20
    s_waitcnt vmcnt(6)
    v_bitop3_b32 v6, v68, v69, s51 bitop3:0x7e
    v_bitop3_b32 v7, v70, v71, s51 bitop3:0x7e
    v_or_b32 v6, v6, v7
    v_cmp_ne_u32 vcc, 0, v6
    s_cbranch_vccz sequential_preLN__ssm_conv_s4d__dense_activation_gelu__prompt_kernel_c1ok21
    s_mov_b32 s72, 0
sequential_preLN__ssm_conv_s4d__dense_activation_gelu__prompt_kernel_c1lp22:
    buffer_load_dwordx4 v[68:71], v4, s[8:11], s7 offen sc1
    s_waitcnt vmcnt(0)
    v_bitop3_b32 v6, v68, v69, s51 bitop3:0x7e
    v_bitop3_b32 v7, v70, v71, s51 bitop3:0x7e
    v_or_b32 v6, v6, v7
    v_cmp_ne_u32 vcc, 0, v6
    s_cbranch_vccz sequential_preLN__ssm_conv_s4d__dense_activation_gelu__prompt_kernel_c1ok21
    s_add_u32 s72, s72, 1
    s_cmp_lt_u32 s72, 40000
    s_cbranch_scc1 sequential_preLN__ssm_conv_s4d__dense_activation_gelu__prompt_kernel_c1lp22
sequential_preLN__ssm_conv_s4d__dense_activation_gelu__prompt_kernel_c1ok21:
sequential_preLN__ssm_conv_s4d__dense_activation_gelu__prompt_kernel_nw20:
    s_waitcnt lgkmcnt(0)
    s_barrier
    s_add_u32 m0, s25, 0
    s_add_u32 s27, s24, 0
    buffer_load_dwordx4 v72, s[8:11], s27 offen offset:0 sc1 lds
    buffer_load_dwordx4 v73, s[8:11], s27 offen offset:1024 sc1 lds
    buffer_load_dwordx4 v72, s[8:11], s27 offen offset:2048 sc1 lds
    buffer_load_dwordx4 v73, s[8:11], s27 offen offset:3072 sc1 lds
    s_add_u32 m0, s25, 16384
    s_add_u32 s27, s24, 16384
    buffer_load_dwordx4 v72, s[8:11], s27 offen offset:0 sc1 lds
    buffer_load_dwordx4 v73, s[8:11], s27 offen offset:1024 sc1 lds
    buffer_load_dwordx4 v72, s[8:11], s27 offen offset:2048 sc1 lds
    buffer_load_dwordx4 v73, s[8:11], s27 offen offset:3072 sc1 lds
    s_waitcnt vmcnt(4)
    s_barrier
    ds_read_b64_tr_b16 v[160:161], v74 offset:0
    ds_read_b64_tr_b16 v[162:163], v74 offset:4096
    ds_read_b64_tr_b16 v[164:165], v75 offset:0
    ds_read_b64_tr_b16 v[166:167], v75 offset:4096
    s_add_u32 m0, s25, 32768
    s_add_u32 s27, s24, 32768
    buffer_load_dwordx4 v72, s[8:11], s27 offen offset:0 sc1 lds
    buffer_load_dwordx4 v73, s[8:11], s27 offen offset:1024 sc1 lds
    buffer_load_dwordx4 v72, s[8:11], s27 offen offset:2048 sc1 lds
    buffer_load_dwordx4 v73, s[8:11], s27 offen offset:3072 sc1 lds
    s_waitcnt lgkmcnt(0)
    v_mfma_f32_16x16x32_bf16 v[140:143], v[156:159], v[160:163], 0
    ds_read_b64_tr_b16 v[168:169], v74 offset:8192
    ds_read_b64_tr_b16 v[170:171], v74 offset:12288
    v_mfma_f32_16x16x32_bf16 v[148:151], v[160:163], v[160:163], 0
    ds_read_b64_tr_b16 v[172:173], v75 offset:8192
    ds_read_b64_tr_b16 v[174:175], v75 offset:12288
    v_mfma_f32_16x16x32_bf16 v[144:147], v[156:159], v[164:167], 0
    v_add_u32 v5, 4096, v5
    buffer_load_dwordx4 a[96:99], v5, s[8:11], s34 offen offset:0 sc1
    v_mfma_f32_16x16x32_bf16 v[152:155], v[164:167], v[164:167], 0
    ds_read_b64_tr_b16 v[204:205], v79 offset:7168
    ds_read_b64_tr_b16 v[206:207], v79 offset:10752
    v_mfma_f32_16x16x32_bf16 v[84:87], v[176:179], v[160:163], 0
    ds_read_b64_tr_b16 v[208:209], v79 offset:7200
    ds_read_b64_tr_b16 v[210:211], v79 offset:10784
    v_mfma_f32_16x16x32_bf16 v[88:91], v[176:179], v[164:167], 0
    ds_read_b64_tr_b16 v[212:213], v79 offset:7232
    ds_read_b64_tr_b16 v[214:215], v79 offset:10816
    v_mfma_f32_16x16x32_bf16 v[92:95], v[180:183], v[160:163], 0
    buffer_load_dwordx4 a[100:103], v5, s[8:11], s34 offen offset:1024 sc1
    v_mfma_f32_16x16x32_bf16 v[96:99], v[180:183], v[164:167], 0
    ds_read_b64_tr_b16 v[216:217], v79 offset:7264
    v_mfma_f32_16x16x32_bf16 v[100:103], v[184:187], v[160:163], 0
    ds_read_b64_tr_b16 v[218:219], v79 offset:10848
    v_mfma_f32_16x16x32_bf16 v[104:107], v[184:187], v[164:167], 0
    ds_read_b64_tr_b16 v[220:221], v79 offset:7296
    v_mfma_f32_16x16x32_bf16 v[108:111], v[188:191], v[160:163], 0
    buffer_load_dwordx4 a[104:107], v5, s[8:11], s34 offen offset:2048 sc1
    v_mfma_f32_16x16x32_bf16 v[112:115], v[188:191], v[164:167], 0
    ds_read_b64_tr_b16 v[222:223], v79 offset:10880
    v_accvgpr_read_b32 v8, a3
    v_mfma_f32_16x16x32_bf16 v[116:119], v[192:195], v[160:163], 0
    ds_read_b64_tr_b16 v[224:225], v79 offset:7328
    v_accvgpr_read_b32 v9, a7
    v_mfma_f32_16x16x32_bf16 v[120:123], v[192:195], v[164:167], 0
    ds_read_b64_tr_b16 v[226:227], v79 offset:10912
    v_bitop3_b32 v7, v8, v9, s50 bitop3:0x7e
    v_mfma_f32_16x16x32_bf16 v[124:127], v[196:199], v[160:163], 0
    buffer_load_dwordx4 a[108:111], v5, s[8:11], s34 offen offset:3072 sc1
    v_mfma_f32_16x16x32_bf16 v[128:131], v[196:199], v[164:167], 0
    ds_read_b64_tr_b16 v[228:229], v79 offset:7360
    v_mfma_f32_16x16x32_bf16 v[132:135], v[200:203], v[160:163], 0
    ds_read_b64_tr_b16 v[230:231], v79 offset:10944
    v_mfma_f32_16x16x32_bf16 v[136:139], v[200:203], v[164:167], 0
    s_waitcnt lgkmcnt(0)
    s_waitcnt vmcnt(8)
    s_barrier
    v_mfma_f32_16x16x32_bf16 v[140:143], v[156:159], v[168:171], v[140:143]
    ds_read_b64_tr_b16 v[160:161], v74 offset:16384
    ds_read_b64_tr_b16 v[162:163], v74 offset:20480
    v_mfma_f32_16x16x32_bf16 v[148:151], v[168:171], v[168:171], v[148:151]
    ds_read_b64_tr_b16 v[164:165], v75 offset:16384
    ds_read_b64_tr_b16 v[166:167], v75 offset:20480
    v_mfma_f32_16x16x32_bf16 v[144:147], v[156:159], v[172:175], v[144:147]
    s_add_u32 m0, s25, 0
    s_add_u32 s27, s24, 49152
    buffer_load_dwordx4 v72, s[8:11], s27 offen offset:0 sc1 lds
    v_mfma_f32_16x16x32_bf16 v[152:155], v[172:175], v[172:175], v[152:155]
    ds_read_b64_tr_b16 v[176:177], v79 offset:14336
    ds_read_b64_tr_b16 v[178:179], v79 offset:17920
    v_mfma_f32_16x16x32_bf16 v[84:87], v[204:207], v[168:171], v[84:87]
    ds_read_b64_tr_b16 v[180:181], v79 offset:14368
    ds_read_b64_tr_b16 v[182:183], v79 offset:17952
    v_mfma_f32_16x16x32_bf16 v[88:91], v[204:207], v[172:175], v[88:91]
    ds_read_b64_tr_b16 v[184:185], v79 offset:14400
    ds_read_b64_tr_b16 v[186:187], v79 offset:17984
    v_mfma_f32_16x16x32_bf16 v[92:95], v[208:211], v[168:171], v[92:95]
    buffer_load_dwordx4 v73, s[8:11], s27 offen offset:1024 sc1 lds
    v_mfma_f32_16x16x32_bf16 v[96:99], v[208:211], v[172:175], v[96:99]
    ds_read_b64_tr_b16 v[188:189], v79 offset:14432
    v_mfma_f32_16x16x32_bf16 v[100:103], v[212:215], v[168:171], v[100:103]
    ds_read_b64_tr_b16 v[190:191], v79 offset:18016
    v_mfma_f32_16x16x32_bf16 v[104:107], v[212:215], v[172:175], v[104:107]
    ds_read_b64_tr_b16 v[192:193], v79 offset:14464
    v_mfma_f32_16x16x32_bf16 v[108:111], v[216:219], v[168:171], v[108:111]
    buffer_load_dwordx4 v72, s[8:11], s27 offen offset:2048 sc1 lds
    v_mfma_f32_16x16x32_bf16 v[112:115], v[216:219], v[172:175], v[112:115]
    ds_read_b64_tr_b16 v[194:195], v79 offset:18048
    v_accvgpr_read_b32 v8, a11
    v_mfma_f32_16x16x32_bf16 v[116:119], v[220:223], v[168:171], v[116:119]
    ds_read_b64_tr_b16 v[196:197], v79 offset:14496
    v_accvgpr_read_b32 v9, a15
    v_mfma_f32_16x16x32_bf16 v[120:123], v[220:223], v[172:175], v[120:123]
    ds_read_b64_tr_b16 v[198:199], v79 offset:18080
    v_bitop3_b32 v8, v8, v9, s50 bitop3:0x7e
    v_mfma_f32_16x16x32_bf16 v[124:127], v[224:227], v[168:171], v[124:127]
    buffer_load_dwordx4 v73, s[8:11], s27 offen offset:3072 sc1 lds
    v_mfma_f32_16x16x32_bf16 v[128:131], v[224:227], v[172:175], v[128:131]
    ds_read_b64_tr_b16 v[200:201], v79 offset:14528
    v_mfma_f32_16x16x32_bf16 v[132:135], v[228:231], v[168:171], v[132:135]
    ds_read_b64_tr_b16 v[202:203], v79 offset:18112
    v_mfma_f32_16x16x32_bf16 v[136:139], v[228:231], v[172:175], v[136:139]
    s_waitcnt lgkmcnt(0)
    v_mfma_f32_16x16x32_bf16 v[140:143], v[156:159], v[160:163], v[140:143]
    ds_read_b64_tr_b16 v[168:169], v74 offset:24576
    ds_read_b64_tr_b16 v[170:171], v74 offset:28672
    v_mfma_f32_16x16x32_bf16 v[148:151], v[160:163], v[160:163], v[148:151]
    ds_read_b64_tr_b16 v[172:173], v75 offset:24576
    ds_read_b64_tr_b16 v[174:175], v75 offset:28672
    v_mfma_f32_16x16x32_bf16 v[144:147], v[156:159], v[164:167], v[144:147]
    v_add_u32 v5, 4096, v5
    buffer_load_dwordx4 a[112:115], v5, s[8:11], s34 offen offset:0 sc1
    v_mfma_f32_16x16x32_bf16 v[152:155], v[164:167], v[164:167], v[152:155]
    ds_read_b64_tr_b16 v[204:205], v79 offset:21504
    ds_read_b64_tr_b16 v[206:207], v79 offset:25088
    v_mfma_f32_16x16x32_bf16 v[84:87], v[176:179], v[160:163], v[84:87]
    ds_read_b64_tr_b16 v[208:209], v79 offset:21536
    ds_read_b64_tr_b16 v[210:211], v79 offset:25120
    v_mfma_f32_16x16x32_bf16 v[88:91], v[176:179], v[164:167], v[88:91]
    ds_read_b64_tr_b16 v[212:213], v79 offset:21568
    ds_read_b64_tr_b16 v[214:215], v79 offset:25152
    v_mfma_f32_16x16x32_bf16 v[92:95], v[180:183], v[160:163], v[92:95]
    buffer_load_dwordx4 a[116:119], v5, s[8:11], s34 offen offset:1024 sc1
    v_mfma_f32_16x16x32_bf16 v[96:99], v[180:183], v[164:167], v[96:99]
    ds_read_b64_tr_b16 v[216:217], v79 offset:21600
    v_mfma_f32_16x16x32_bf16 v[100:103], v[184:187], v[160:163], v[100:103]
    ds_read_b64_tr_b16 v[218:219], v79 offset:25184
    v_mfma_f32_16x16x32_bf16 v[104:107], v[184:187], v[164:167], v[104:107]
    ds_read_b64_tr_b16 v[220:221], v79 offset:21632
    v_mfma_f32_16x16x32_bf16 v[108:111], v[188:191], v[160:163], v[108:111]
    buffer_load_dwordx4 a[120:123], v5, s[8:11], s34 offen offset:2048 sc1
    v_mfma_f32_16x16x32_bf16 v[112:115], v[188:191], v[164:167], v[112:115]
    ds_read_b64_tr_b16 v[222:223], v79 offset:25216
    v_or_b32 v7, v7, v8
    v_mfma_f32_16x16x32_bf16 v[116:119], v[192:195], v[160:163], v[116:119]
    ds_read_b64_tr_b16 v[224:225], v79 offset:21664
    v_accvgpr_read_b32 v8, a19
    v_mfma_f32_16x16x32_bf16 v[120:123], v[192:195], v[164:167], v[120:123]
    ds_read_b64_tr_b16 v[226:227], v79 offset:25248
    v_accvgpr_read_b32 v9, a23
    v_mfma_f32_16x16x32_bf16 v[124:127], v[196:199], v[160:163], v[124:127]
    buffer_load_dwordx4 a[124:127], v5, s[8:11], s34 offen offset:3072 sc1
    v_mfma_f32_16x16x32_bf16 v[128:131], v[196:199], v[164:167], v[128:131]
    ds_read_b64_tr_b16 v[228:229], v79 offset:21696
    v_mfma_f32_16x16x32_bf16 v[132:135], v[200:203], v[160:163], v[132:135]
    ds_read_b64_tr_b16 v[230:231], v79 offset:25280
    v_mfma_f32_16x16x32_bf16 v[136:139], v[200:203], v[164:167], v[136:139]
    s_waitcnt lgkmcnt(0)
    s_waitcnt vmcnt(12)
    s_barrier
    v_mfma_f32_16x16x32_bf16 v[140:143], v[156:159], v[168:171], v[140:143]
    ds_read_b64_tr_b16 v[160:161], v74 offset:32768
    ds_read_b64_tr_b16 v[162:163], v74 offset:36864
    v_mfma_f32_16x16x32_bf16 v[148:151], v[168:171], v[168:171], v[148:151]
    ds_read_b64_tr_b16 v[164:165], v75 offset:32768
    ds_read_b64_tr_b16 v[166:167], v75 offset:36864
    v_mfma_f32_16x16x32_bf16 v[144:147], v[156:159], v[172:175], v[144:147]
    s_add_u32 m0, s25, 16384
    s_add_u32 s27, s24, 65536
    buffer_load_dwordx4 v72, s[8:11], s27 offen offset:0 sc1 lds
    v_mfma_f32_16x16x32_bf16 v[152:155], v[172:175], v[172:175], v[152:155]
    ds_read_b64_tr_b16 v[176:177], v79 offset:28672
    ds_read_b64_tr_b16 v[178:179], v79 offset:32256
    v_mfma_f32_16x16x32_bf16 v[84:87], v[204:207], v[168:171], v[84:87]
    ds_read_b64_tr_b16 v[180:181], v79 offset:28704
    ds_read_b64_tr_b16 v[182:183], v79 offset:32288
    v_mfma_f32_16x16x32_bf16 v[88:91], v[204:207], v[172:175], v[88:91]
    ds_read_b64_tr_b16 v[184:185], v79 offset:28736
    ds_read_b64_tr_b16 v[186:187], v79 offset:32320
    v_mfma_f32_16x16x32_bf16 v[92:95], v[208:211], v[168:171], v[92:95]
    buffer_load_dwordx4 v73, s[8:11], s27 offen offset:1024 sc1 lds
    v_mfma_f32_16x16x32_bf16 v[96:99], v[208:211], v[172:175], v[96:99]
    ds_read_b64_tr_b16 v[188:189], v79 offset:28768
    v_mfma_f32_16x16x32_bf16 v[100:103], v[212:215], v[168:171], v[100:103]
    ds_read_b64_tr_b16 v[190:191], v79 offset:32352
    v_mfma_f32_16x16x32_bf16 v[104:107], v[212:215], v[172:175], v[104:107]
    ds_read_b64_tr_b16 v[192:193], v79 offset:28800
    v_mfma_f32_16x16x32_bf16 v[108:111], v[216:219], v[168:171], v[108:111]
    buffer_load_dwordx4 v72, s[8:11], s27 offen offset:2048 sc1 lds
    v_mfma_f32_16x16x32_bf16 v[112:115], v[216:219], v[172:175], v[112:115]
    ds_read_b64_tr_b16 v[194:195], v79 offset:32384
    v_bitop3_b32 v8, v8, v9, s50 bitop3:0x7e
    v_mfma_f32_16x16x32_bf16 v[116:119], v[220:223], v[168:171], v[116:119]
    ds_read_b64_tr_b16 v[196:197], v79 offset:28832
    v_or_b32 v7, v7, v8
    v_mfma_f32_16x16x32_bf16 v[120:123], v[220:223], v[172:175], v[120:123]
    ds_read_b64_tr_b16 v[198:199], v79 offset:32416
    v_accvgpr_read_b32 v8, a27
    v_mfma_f32_16x16x32_bf16 v[124:127], v[224:227], v[168:171], v[124:127]
    buffer_load_dwordx4 v73, s[8:11], s27 offen offset:3072 sc1 lds
    v_mfma_f32_16x16x32_bf16 v[128:131], v[224:227], v[172:175], v[128:131]
    ds_read_b64_tr_b16 v[200:201], v79 offset:28864
    v_mfma_f32_16x16x32_bf16 v[132:135], v[228:231], v[168:171], v[132:135]
    ds_read_b64_tr_b16 v[202:203], v79 offset:32448
    v_mfma_f32_16x16x32_bf16 v[136:139], v[228:231], v[172:175], v[136:139]
    s_waitcnt lgkmcnt(0)
    v_mfma_f32_16x16x32_bf16 v[140:143], v[156:159], v[160:163], v[140:143]
    ds_read_b64_tr_b16 v[168:169], v74 offset:40960
    ds_read_b64_tr_b16 v[170:171], v74 offset:45056
    v_mfma_f32_16x16x32_bf16 v[148:151], v[160:163], v[160:163], v[148:151]
    ds_read_b64_tr_b16 v[172:173], v75 offset:40960
    ds_read_b64_tr_b16 v[174:175], v75 offset:45056
    v_mfma_f32_16x16x32_bf16 v[144:147], v[156:159], v[164:167], v[144:147]
    v_add_u32 v5, 4096, v5
    buffer_load_dwordx4 a[128:131], v5, s[8:11], s34 offen offset:0 sc1
    v_mfma_f32_16x16x32_bf16 v[152:155], v[164:167], v[164:167], v[152:155]
    ds_read_b64_tr_b16 v[204:205], v79 offset:35840
    ds_read_b64_tr_b16 v[206:207], v79 offset:39424
    v_mfma_f32_16x16x32_bf16 v[84:87], v[176:179], v[160:163], v[84:87]
    ds_read_b64_tr_b16 v[208:209], v79 offset:35872
    ds_read_b64_tr_b16 v[210:211], v79 offset:39456
    v_mfma_f32_16x16x32_bf16 v[88:91], v[176:179], v[164:167], v[88:91]
    ds_read_b64_tr_b16 v[212:213], v79 offset:35904
    ds_read_b64_tr_b16 v[214:215], v79 offset:39488
    v_mfma_f32_16x16x32_bf16 v[92:95], v[180:183], v[160:163], v[92:95]
    buffer_load_dwordx4 a[132:135], v5, s[8:11], s34 offen offset:1024 sc1
    v_mfma_f32_16x16x32_bf16 v[96:99], v[180:183], v[164:167], v[96:99]
    ds_read_b64_tr_b16 v[216:217], v79 offset:35936
    v_mfma_f32_16x16x32_bf16 v[100:103], v[184:187], v[160:163], v[100:103]
    ds_read_b64_tr_b16 v[218:219], v79 offset:39520
    v_mfma_f32_16x16x32_bf16 v[104:107], v[184:187], v[164:167], v[104:107]
    ds_read_b64_tr_b16 v[220:221], v79 offset:35968
    v_mfma_f32_16x16x32_bf16 v[108:111], v[188:191], v[160:163], v[108:111]
    buffer_load_dwordx4 a[136:139], v5, s[8:11], s34 offen offset:2048 sc1
    v_mfma_f32_16x16x32_bf16 v[112:115], v[188:191], v[164:167], v[112:115]
    ds_read_b64_tr_b16 v[222:223], v79 offset:39552
    v_accvgpr_read_b32 v9, a31
    v_mfma_f32_16x16x32_bf16 v[116:119], v[192:195], v[160:163], v[116:119]
    ds_read_b64_tr_b16 v[224:225], v79 offset:36000
    v_bitop3_b32 v8, v8, v9, s50 bitop3:0x7e
    v_mfma_f32_16x16x32_bf16 v[120:123], v[192:195], v[164:167], v[120:123]
    ds_read_b64_tr_b16 v[226:227], v79 offset:39584
    v_or_b32 v7, v7, v8
    v_mfma_f32_16x16x32_bf16 v[124:127], v[196:199], v[160:163], v[124:127]
    buffer_load_dwordx4 a[140:143], v5, s[8:11], s34 offen offset:3072 sc1
    v_mfma_f32_16x16x32_bf16 v[128:131], v[196:199], v[164:167], v[128:131]
    ds_read_b64_tr_b16 v[228:229], v79 offset:36032
    v_mfma_f32_16x16x32_bf16 v[132:135], v[200:203], v[160:163], v[132:135]
    ds_read_b64_tr_b16 v[230:231], v79 offset:39616
    v_mfma_f32_16x16x32_bf16 v[136:139], v[200:203], v[164:167], v[136:139]
    s_waitcnt lgkmcnt(0)
    s_waitcnt vmcnt(12)
    s_barrier
    v_mfma_f32_16x16x32_bf16 v[140:143], v[156:159], v[168:171], v[140:143]
    ds_read_b64_tr_b16 v[160:161], v74 offset:0
    ds_read_b64_tr_b16 v[162:163], v74 offset:4096
    v_mfma_f32_16x16x32_bf16 v[148:151], v[168:171], v[168:171], v[148:151]
    ds_read_b64_tr_b16 v[164:165], v75 offset:0
    ds_read_b64_tr_b16 v[166:167], v75 offset:4096
    v_mfma_f32_16x16x32_bf16 v[144:147], v[156:159], v[172:175], v[144:147]
    s_add_u32 m0, s25, 32768
    s_add_u32 s27, s24, 81920
    buffer_load_dwordx4 v72, s[8:11], s27 offen offset:0 sc1 lds
    v_mfma_f32_16x16x32_bf16 v[152:155], v[172:175], v[172:175], v[152:155]
    ds_read_b64_tr_b16 v[176:177], v79 offset:43008
    ds_read_b64_tr_b16 v[178:179], v79 offset:46592
    v_mfma_f32_16x16x32_bf16 v[84:87], v[204:207], v[168:171], v[84:87]
    ds_read_b64_tr_b16 v[180:181], v79 offset:43040
    ds_read_b64_tr_b16 v[182:183], v79 offset:46624
    v_mfma_f32_16x16x32_bf16 v[88:91], v[204:207], v[172:175], v[88:91]
    ds_read_b64_tr_b16 v[184:185], v79 offset:43072
    ds_read_b64_tr_b16 v[186:187], v79 offset:46656
    v_mfma_f32_16x16x32_bf16 v[92:95], v[208:211], v[168:171], v[92:95]
    buffer_load_dwordx4 v73, s[8:11], s27 offen offset:1024 sc1 lds
    v_mfma_f32_16x16x32_bf16 v[96:99], v[208:211], v[172:175], v[96:99]
    ds_read_b64_tr_b16 v[188:189], v79 offset:43104
    v_mfma_f32_16x16x32_bf16 v[100:103], v[212:215], v[168:171], v[100:103]
    ds_read_b64_tr_b16 v[190:191], v79 offset:46688
    v_mfma_f32_16x16x32_bf16 v[104:107], v[212:215], v[172:175], v[104:107]
    ds_read_b64_tr_b16 v[192:193], v79 offset:43136
    v_mfma_f32_16x16x32_bf16 v[108:111], v[216:219], v[168:171], v[108:111]
    buffer_load_dwordx4 v72, s[8:11], s27 offen offset:2048 sc1 lds
    v_mfma_f32_16x16x32_bf16 v[112:115], v[216:219], v[172:175], v[112:115]
    ds_read_b64_tr_b16 v[194:195], v79 offset:46720
    v_accvgpr_read_b32 v8, a35
    v_mfma_f32_16x16x32_bf16 v[116:119], v[220:223], v[168:171], v[116:119]
    ds_read_b64_tr_b16 v[196:197], v79 offset:43168
    v_accvgpr_read_b32 v9, a39
    v_mfma_f32_16x16x32_bf16 v[120:123], v[220:223], v[172:175], v[120:123]
    ds_read_b64_tr_b16 v[198:199], v79 offset:46752
    v_bitop3_b32 v8, v8, v9, s50 bitop3:0x7e
    v_mfma_f32_16x16x32_bf16 v[124:127], v[224:227], v[168:171], v[124:127]
    buffer_load_dwordx4 v73, s[8:11], s27 offen offset:3072 sc1 lds
    v_mfma_f32_16x16x32_bf16 v[128:131], v[224:227], v[172:175], v[128:131]
    ds_read_b64_tr_b16 v[200:201], v79 offset:43200
    v_mfma_f32_16x16x32_bf16 v[132:135], v[228:231], v[168:171], v[132:135]
    ds_read_b64_tr_b16 v[202:203], v79 offset:46784
    v_mfma_f32_16x16x32_bf16 v[136:139], v[228:231], v[172:175], v[136:139]
    s_waitcnt lgkmcnt(0)
    v_mfma_f32_16x16x32_bf16 v[140:143], v[156:159], v[160:163], v[140:143]
    ds_read_b64_tr_b16 v[168:169], v74 offset:8192
    ds_read_b64_tr_b16 v[170:171], v74 offset:12288
    v_mfma_f32_16x16x32_bf16 v[148:151], v[160:163], v[160:163], v[148:151]
    ds_read_b64_tr_b16 v[172:173], v75 offset:8192
    ds_read_b64_tr_b16 v[174:175], v75 offset:12288
    v_mfma_f32_16x16x32_bf16 v[144:147], v[156:159], v[164:167], v[144:147]
    v_add_u32 v5, 4096, v5
    buffer_load_dwordx4 a[144:147], v5, s[8:11], s34 offen offset:0 sc1
    v_mfma_f32_16x16x32_bf16 v[152:155], v[164:167], v[164:167], v[152:155]
    ds_read_b64_tr_b16 v[204:205], v79 offset:50176
    ds_read_b64_tr_b16 v[206:207], v79 offset:53760
    v_mfma_f32_16x16x32_bf16 v[84:87], v[176:179], v[160:163], v[84:87]
    ds_read_b64_tr_b16 v[208:209], v79 offset:50208
    ds_read_b64_tr_b16 v[210:211], v79 offset:53792
    v_mfma_f32_16x16x32_bf16 v[88:91], v[176:179], v[164:167], v[88:91]
    ds_read_b64_tr_b16 v[212:213], v79 offset:50240
    ds_read_b64_tr_b16 v[214:215], v79 offset:53824
    v_mfma_f32_16x16x32_bf16 v[92:95], v[180:183], v[160:163], v[92:95]
    buffer_load_dwordx4 a[148:151], v5, s[8:11], s34 offen offset:1024 sc1
    v_mfma_f32_16x16x32_bf16 v[96:99], v[180:183], v[164:167], v[96:99]
    ds_read_b64_tr_b16 v[216:217], v79 offset:50272
    v_mfma_f32_16x16x32_bf16 v[100:103], v[184:187], v[160:163], v[100:103]
    ds_read_b64_tr_b16 v[218:219], v79 offset:53856
    v_mfma_f32_16x16x32_bf16 v[104:107], v[184:187], v[164:167], v[104:107]
    ds_read_b64_tr_b16 v[220:221], v79 offset:50304
    v_mfma_f32_16x16x32_bf16 v[108:111], v[188:191], v[160:163], v[108:111]
    buffer_load_dwordx4 a[152:155], v5, s[8:11], s34 offen offset:2048 sc1
    v_mfma_f32_16x16x32_bf16 v[112:115], v[188:191], v[164:167], v[112:115]
    ds_read_b64_tr_b16 v[222:223], v79 offset:53888
    v_or_b32 v7, v7, v8
    v_mfma_f32_16x16x32_bf16 v[116:119], v[192:195], v[160:163], v[116:119]
    ds_read_b64_tr_b16 v[224:225], v79 offset:50336
    v_accvgpr_read_b32 v8, a43
    v_mfma_f32_16x16x32_bf16 v[120:123], v[192:195], v[164:167], v[120:123]
    ds_read_b64_tr_b16 v[226:227], v79 offset:53920
    v_accvgpr_read_b32 v9, a47
    v_mfma_f32_16x16x32_bf16 v[124:127], v[196:199], v[160:163], v[124:127]
    buffer_load_dwordx4 a[156:159], v5, s[8:11], s34 offen offset:3072 sc1
    v_mfma_f32_16x16x32_bf16 v[128:131], v[196:199], v[164:167], v[128:131]
    ds_read_b64_tr_b16 v[228:229], v79 offset:50368
    v_mfma_f32_16x16x32_bf16 v[132:135], v[200:203], v[160:163], v[132:135]
    ds_read_b64_tr_b16 v[230:231], v79 offset:53952
    v_mfma_f32_16x16x32_bf16 v[136:139], v[200:203], v[164:167], v[136:139]
    s_waitcnt lgkmcnt(0)
    s_waitcnt vmcnt(12)
    s_barrier
    v_mfma_f32_16x16x32_bf16 v[140:143], v[156:159], v[168:171], v[140:143]
    ds_read_b64_tr_b16 v[160:161], v74 offset:16384
    ds_read_b64_tr_b16 v[162:163], v74 offset:20480
    v_mfma_f32_16x16x32_bf16 v[148:151], v[168:171], v[168:171], v[148:151]
    ds_read_b64_tr_b16 v[164:165], v75 offset:16384
    ds_read_b64_tr_b16 v[166:167], v75 offset:20480
    v_mfma_f32_16x16x32_bf16 v[144:147], v[156:159], v[172:175], v[144:147]
    s_add_u32 m0, s25, 0
    s_add_u32 s27, s24, 98304
    buffer_load_dwordx4 v72, s[8:11], s27 offen offset:0 sc1 lds
    v_mfma_f32_16x16x32_bf16 v[152:155], v[172:175], v[172:175], v[152:155]
    ds_read_b64_tr_b16 v[176:177], v80 offset:0
    ds_read_b64_tr_b16 v[178:179], v80 offset:3584
    v_mfma_f32_16x16x32_bf16 v[84:87], v[204:207], v[168:171], v[84:87]
    ds_read_b64_tr_b16 v[180:181], v80 offset:32
    ds_read_b64_tr_b16 v[182:183], v80 offset:3616
    v_mfma_f32_16x16x32_bf16 v[88:91], v[204:207], v[172:175], v[88:91]
    ds_read_b64_tr_b16 v[184:185], v80 offset:64
    ds_read_b64_tr_b16 v[186:187], v80 offset:3648
    v_mfma_f32_16x16x32_bf16 v[92:95], v[208:211], v[168:171], v[92:95]
    buffer_load_dwordx4 v73, s[8:11], s27 offen offset:1024 sc1 lds
    v_mfma_f32_16x16x32_bf16 v[96:99], v[208:211], v[172:175], v[96:99]
    ds_read_b64_tr_b16 v[188:189], v80 offset:96
    v_mfma_f32_16x16x32_bf16 v[100:103], v[212:215], v[168:171], v[100:103]
    ds_read_b64_tr_b16 v[190:191], v80 offset:3680
    v_mfma_f32_16x16x32_bf16 v[104:107], v[212:215], v[172:175], v[104:107]
    ds_read_b64_tr_b16 v[192:193], v80 offset:128
    v_mfma_f32_16x16x32_bf16 v[108:111], v[216:219], v[168:171], v[108:111]
    buffer_load_dwordx4 v72, s[8:11], s27 offen offset:2048 sc1 lds
    v_mfma_f32_16x16x32_bf16 v[112:115], v[216:219], v[172:175], v[112:115]
    ds_read_b64_tr_b16 v[194:195], v80 offset:3712
    v_bitop3_b32 v8, v8, v9, s50 bitop3:0x7e
    v_mfma_f32_16x16x32_bf16 v[116:119], v[220:223], v[168:171], v[116:119]
    ds_read_b64_tr_b16 v[196:197], v80 offset:160
    v_or_b32 v7, v7, v8
    v_mfma_f32_16x16x32_bf16 v[120:123], v[220:223], v[172:175], v[120:123]
    ds_read_b64_tr_b16 v[198:199], v80 offset:3744
    v_accvgpr_read_b32 v8, a51
    v_mfma_f32_16x16x32_bf16 v[124:127], v[224:227], v[168:171], v[124:127]
    buffer_load_dwordx4 v73, s[8:11], s27 offen offset:3072 sc1 lds
    v_mfma_f32_16x16x32_bf16 v[128:131], v[224:227], v[172:175], v[128:131]
    ds_read_b64_tr_b16 v[200:201], v80 offset:192
    v_mfma_f32_16x16x32_bf16 v[132:135], v[228:231], v[168:171], v[132:135]
    ds_read_b64_tr_b16 v[202:203], v80 offset:3776
    v_mfma_f32_16x16x32_bf16 v[136:139], v[228:231], v[172:175], v[136:139]
    s_waitcnt lgkmcnt(0)
    v_mfma_f32_16x16x32_bf16 v[140:143], v[156:159], v[160:163], v[140:143]
    ds_read_b64_tr_b16 v[168:169], v74 offset:24576
    ds_read_b64_tr_b16 v[170:171], v74 offset:28672
    v_mfma_f32_16x16x32_bf16 v[148:151], v[160:163], v[160:163], v[148:151]
    ds_read_b64_tr_b16 v[172:173], v75 offset:24576
    ds_read_b64_tr_b16 v[174:175], v75 offset:28672
    v_mfma_f32_16x16x32_bf16 v[144:147], v[156:159], v[164:167], v[144:147]
    v_add_u32 v5, 4096, v5
    buffer_load_dwordx4 a[160:163], v5, s[8:11], s34 offen offset:0 sc1
    v_mfma_f32_16x16x32_bf16 v[152:155], v[164:167], v[164:167], v[152:155]
    ds_read_b64_tr_b16 v[204:205], v80 offset:7168
    ds_read_b64_tr_b16 v[206:207], v80 offset:10752
    v_mfma_f32_16x16x32_bf16 v[84:87], v[176:179], v[160:163], v[84:87]
    ds_read_b64_tr_b16 v[208:209], v80 offset:7200
    ds_read_b64_tr_b16 v[210:211], v80 offset:10784
    v_mfma_f32_16x16x32_bf16 v[88:91], v[176:179], v[164:167], v[88:91]
    ds_read_b64_tr_b16 v[212:213], v80 offset:7232
    ds_read_b64_tr_b16 v[214:215], v80 offset:10816
    v_mfma_f32_16x16x32_bf16 v[92:95], v[180:183], v[160:163], v[92:95]
    buffer_load_dwordx4 a[164:167], v5, s[8:11], s34 offen offset:1024 sc1
    v_mfma_f32_16x16x32_bf16 v[96:99], v[180:183], v[164:167], v[96:99]
    ds_read_b64_tr_b16 v[216:217], v80 offset:7264
    v_mfma_f32_16x16x32_bf16 v[100:103], v[184:187], v[160:163], v[100:103]
    ds_read_b64_tr_b16 v[218:219], v80 offset:10848
    v_mfma_f32_16x16x32_bf16 v[104:107], v[184:187], v[164:167], v[104:107]
    ds_read_b64_tr_b16 v[220:221], v80 offset:7296
    v_mfma_f32_16x16x32_bf16 v[108:111], v[188:191], v[160:163], v[108:111]
    buffer_load_dwordx4 a[168:171], v5, s[8:11], s34 offen offset:2048 sc1
    v_mfma_f32_16x16x32_bf16 v[112:115], v[188:191], v[164:167], v[112:115]
    ds_read_b64_tr_b16 v[222:223], v80 offset:10880
    v_accvgpr_read_b32 v9, a55
    v_mfma_f32_16x16x32_bf16 v[116:119], v[192:195], v[160:163], v[116:119]
    ds_read_b64_tr_b16 v[224:225], v80 offset:7328
    v_bitop3_b32 v8, v8, v9, s50 bitop3:0x7e
    v_mfma_f32_16x16x32_bf16 v[120:123], v[192:195], v[164:167], v[120:123]
    ds_read_b64_tr_b16 v[226:227], v80 offset:10912
    v_or_b32 v7, v7, v8
    v_mfma_f32_16x16x32_bf16 v[124:127], v[196:199], v[160:163], v[124:127]
    buffer_load_dwordx4 a[172:175], v5, s[8:11], s34 offen offset:3072 sc1
    v_mfma_f32_16x16x32_bf16 v[128:131], v[196:199], v[164:167], v[128:131]
    ds_read_b64_tr_b16 v[228:229], v80 offset:7360
    v_mfma_f32_16x16x32_bf16 v[132:135], v[200:203], v[160:163], v[132:135]
    ds_read_b64_tr_b16 v[230:231], v80 offset:10944
    v_mfma_f32_16x16x32_bf16 v[136:139], v[200:203], v[164:167], v[136:139]
    s_waitcnt lgkmcnt(0)
    s_waitcnt vmcnt(12)
    s_barrier
    v_mfma_f32_16x16x32_bf16 v[140:143], v[156:159], v[168:171], v[140:143]
    ds_read_b64_tr_b16 v[160:161], v74 offset:32768
    ds_read_b64_tr_b16 v[162:163], v74 offset:36864
    v_mfma_f32_16x16x32_bf16 v[148:151], v[168:171], v[168:171], v[148:151]
    ds_read_b64_tr_b16 v[164:165], v75 offset:32768
    ds_read_b64_tr_b16 v[166:167], v75 offset:36864
    v_mfma_f32_16x16x32_bf16 v[144:147], v[156:159], v[172:175], v[144:147]
    s_add_u32 m0, s25, 16384
    s_add_u32 s27, s24, 114688
    buffer_load_dwordx4 v72, s[8:11], s27 offen offset:0 sc1 lds
    v_mfma_f32_16x16x32_bf16 v[152:155], v[172:175], v[172:175], v[152:155]
    ds_read_b64_tr_b16 v[176:177], v80 offset:14336
    ds_read_b64_tr_b16 v[178:179], v80 offset:17920
    v_mfma_f32_16x16x32_bf16 v[84:87], v[204:207], v[168:171], v[84:87]
    ds_read_b64_tr_b16 v[180:181], v80 offset:14368
    ds_read_b64_tr_b16 v[182:183], v80 offset:17952
    v_mfma_f32_16x16x32_bf16 v[88:91], v[204:207], v[172:175], v[88:91]
    ds_read_b64_tr_b16 v[184:185], v80 offset:14400
    ds_read_b64_tr_b16 v[186:187], v80 offset:17984
    v_mfma_f32_16x16x32_bf16 v[92:95], v[208:211], v[168:171], v[92:95]
    buffer_load_dwordx4 v73, s[8:11], s27 offen offset:1024 sc1 lds
    v_mfma_f32_16x16x32_bf16 v[96:99], v[208:211], v[172:175], v[96:99]
    ds_read_b64_tr_b16 v[188:189], v80 offset:14432
    v_mfma_f32_16x16x32_bf16 v[100:103], v[212:215], v[168:171], v[100:103]
    ds_read_b64_tr_b16 v[190:191], v80 offset:18016
    v_mfma_f32_16x16x32_bf16 v[104:107], v[212:215], v[172:175], v[104:107]
    ds_read_b64_tr_b16 v[192:193], v80 offset:14464
    v_mfma_f32_16x16x32_bf16 v[108:111], v[216:219], v[168:171], v[108:111]
    buffer_load_dwordx4 v72, s[8:11], s27 offen offset:2048 sc1 lds
    v_mfma_f32_16x16x32_bf16 v[112:115], v[216:219], v[172:175], v[112:115]
    ds_read_b64_tr_b16 v[194:195], v80 offset:18048
    v_accvgpr_read_b32 v8, a59
    v_mfma_f32_16x16x32_bf16 v[116:119], v[220:223], v[168:171], v[116:119]
    ds_read_b64_tr_b16 v[196:197], v80 offset:14496
    v_accvgpr_read_b32 v9, a63
    v_mfma_f32_16x16x32_bf16 v[120:123], v[220:223], v[172:175], v[120:123]
    ds_read_b64_tr_b16 v[198:199], v80 offset:18080
    v_bitop3_b32 v8, v8, v9, s50 bitop3:0x7e
    v_mfma_f32_16x16x32_bf16 v[124:127], v[224:227], v[168:171], v[124:127]
    buffer_load_dwordx4 v73, s[8:11], s27 offen offset:3072 sc1 lds
    v_mfma_f32_16x16x32_bf16 v[128:131], v[224:227], v[172:175], v[128:131]
    ds_read_b64_tr_b16 v[200:201], v80 offset:14528
    v_mfma_f32_16x16x32_bf16 v[132:135], v[228:231], v[168:171], v[132:135]
    ds_read_b64_tr_b16 v[202:203], v80 offset:18112
    v_mfma_f32_16x16x32_bf16 v[136:139], v[228:231], v[172:175], v[136:139]
    s_waitcnt lgkmcnt(0)
    v_mfma_f32_16x16x32_bf16 v[140:143], v[156:159], v[160:163], v[140:143]
    ds_read_b64_tr_b16 v[168:169], v74 offset:40960
    ds_read_b64_tr_b16 v[170:171], v74 offset:45056
    v_mfma_f32_16x16x32_bf16 v[148:151], v[160:163], v[160:163], v[148:151]
    ds_read_b64_tr_b16 v[172:173], v75 offset:40960
    ds_read_b64_tr_b16 v[174:175], v75 offset:45056
    v_mfma_f32_16x16x32_bf16 v[144:147], v[156:159], v[164:167], v[144:147]
    v_add_u32 v5, 4096, v5
    buffer_load_dwordx4 a[176:179], v5, s[8:11], s34 offen offset:0 sc1
    v_mfma_f32_16x16x32_bf16 v[152:155], v[164:167], v[164:167], v[152:155]
    ds_read_b64_tr_b16 v[204:205], v80 offset:21504
    ds_read_b64_tr_b16 v[206:207], v80 offset:25088
    v_mfma_f32_16x16x32_bf16 v[84:87], v[176:179], v[160:163], v[84:87]
    ds_read_b64_tr_b16 v[208:209], v80 offset:21536
    ds_read_b64_tr_b16 v[210:211], v80 offset:25120
    v_mfma_f32_16x16x32_bf16 v[88:91], v[176:179], v[164:167], v[88:91]
    ds_read_b64_tr_b16 v[212:213], v80 offset:21568
    ds_read_b64_tr_b16 v[214:215], v80 offset:25152
    v_mfma_f32_16x16x32_bf16 v[92:95], v[180:183], v[160:163], v[92:95]
    buffer_load_dwordx4 a[180:183], v5, s[8:11], s34 offen offset:1024 sc1
    v_mfma_f32_16x16x32_bf16 v[96:99], v[180:183], v[164:167], v[96:99]
    ds_read_b64_tr_b16 v[216:217], v80 offset:21600
    v_mfma_f32_16x16x32_bf16 v[100:103], v[184:187], v[160:163], v[100:103]
    ds_read_b64_tr_b16 v[218:219], v80 offset:25184
    v_mfma_f32_16x16x32_bf16 v[104:107], v[184:187], v[164:167], v[104:107]
    ds_read_b64_tr_b16 v[220:221], v80 offset:21632
    v_mfma_f32_16x16x32_bf16 v[108:111], v[188:191], v[160:163], v[108:111]
    buffer_load_dwordx4 a[184:187], v5, s[8:11], s34 offen offset:2048 sc1
    v_mfma_f32_16x16x32_bf16 v[112:115], v[188:191], v[164:167], v[112:115]
    ds_read_b64_tr_b16 v[222:223], v80 offset:25216
    v_or_b32 v7, v7, v8
    v_mfma_f32_16x16x32_bf16 v[116:119], v[192:195], v[160:163], v[116:119]
    ds_read_b64_tr_b16 v[224:225], v80 offset:21664
    v_accvgpr_read_b32 v8, a67
    v_mfma_f32_16x16x32_bf16 v[120:123], v[192:195], v[164:167], v[120:123]
    ds_read_b64_tr_b16 v[226:227], v80 offset:25248
    v_accvgpr_read_b32 v9, a71
    v_mfma_f32_16x16x32_bf16 v[124:127], v[196:199], v[160:163], v[124:127]
    buffer_load_dwordx4 a[188:191], v5, s[8:11], s34 offen offset:3072 sc1
    v_mfma_f32_16x16x32_bf16 v[128:131], v[196:199], v[164:167], v[128:131]
    ds_read_b64_tr_b16 v[228:229], v80 offset:21696
    v_mfma_f32_16x16x32_bf16 v[132:135], v[200:203], v[160:163], v[132:135]
    ds_read_b64_tr_b16 v[230:231], v80 offset:25280
    v_mfma_f32_16x16x32_bf16 v[136:139], v[200:203], v[164:167], v[136:139]
    s_waitcnt lgkmcnt(0)
    s_waitcnt vmcnt(12)
    s_barrier
    v_mfma_f32_16x16x32_bf16 v[140:143], v[156:159], v[168:171], v[140:143]
    ds_read_b64_tr_b16 v[160:161], v74 offset:0
    ds_read_b64_tr_b16 v[162:163], v74 offset:4096
    v_mfma_f32_16x16x32_bf16 v[148:151], v[168:171], v[168:171], v[148:151]
    ds_read_b64_tr_b16 v[164:165], v75 offset:0
    ds_read_b64_tr_b16 v[166:167], v75 offset:4096
    v_mfma_f32_16x16x32_bf16 v[144:147], v[156:159], v[172:175], v[144:147]
    s_add_u32 m0, s5, 0
    s_add_u32 s27, s4, 0
    buffer_load_dwordx4 v234, s[8:11], s27 offen sc1 lds
    v_mfma_f32_16x16x32_bf16 v[152:155], v[172:175], v[172:175], v[152:155]
    ds_read_b64_tr_b16 v[176:177], v80 offset:28672
    ds_read_b64_tr_b16 v[178:179], v80 offset:32256
    v_mfma_f32_16x16x32_bf16 v[84:87], v[204:207], v[168:171], v[84:87]
    ds_read_b64_tr_b16 v[180:181], v80 offset:28704
    ds_read_b64_tr_b16 v[182:183], v80 offset:32288
    v_mfma_f32_16x16x32_bf16 v[88:91], v[204:207], v[172:175], v[88:91]
    ds_read_b64_tr_b16 v[184:185], v80 offset:28736
    ds_read_b64_tr_b16 v[186:187], v80 offset:32320
    v_mfma_f32_16x16x32_bf16 v[92:95], v[208:211], v[168:171], v[92:95]
    ds_read_b64_tr_b16 v[188:189], v80 offset:28768
    v_mfma_f32_16x16x32_bf16 v[96:99], v[208:211], v[172:175], v[96:99]
    ds_read_b64_tr_b16 v[190:191], v80 offset:32352
    v_mfma_f32_16x16x32_bf16 v[100:103], v[212:215], v[168:171], v[100:103]
    s_add_u32 m0, s5, 1024
    s_add_u32 s27, s4, 8192
    buffer_load_dwordx4 v234, s[8:11], s27 offen sc1 lds
    v_mfma_f32_16x16x32_bf16 v[104:107], v[212:215], v[172:175], v[104:107]
    ds_read_b64_tr_b16 v[192:193], v80 offset:28800
    v_mfma_f32_16x16x32_bf16 v[108:111], v[216:219], v[168:171], v[108:111]
    ds_read_b64_tr_b16 v[194:195], v80 offset:32384
    v_mfma_f32_16x16x32_bf16 v[112:115], v[216:219], v[172:175], v[112:115]
    ds_read_b64_tr_b16 v[196:197], v80 offset:28832
    v_bitop3_b32 v8, v8, v9, s50 bitop3:0x7e
    v_mfma_f32_16x16x32_bf16 v[116:119], v[220:223], v[168:171], v[116:119]
    ds_read_b64_tr_b16 v[198:199], v80 offset:32416
    v_or_b32 v7, v7, v8
    v_mfma_f32_16x16x32_bf16 v[120:123], v[220:223], v[172:175], v[120:123]
    ds_read_b64_tr_b16 v[200:201], v80 offset:28864
    v_accvgpr_read_b32 v8, a75
    v_mfma_f32_16x16x32_bf16 v[124:127], v[224:227], v[168:171], v[124:127]
    ds_read_b64_tr_b16 v[202:203], v80 offset:32448
    v_mfma_f32_16x16x32_bf16 v[128:131], v[224:227], v[172:175], v[128:131]
    v_mfma_f32_16x16x32_bf16 v[132:135], v[228:231], v[168:171], v[132:135]
    v_mfma_f32_16x16x32_bf16 v[136:139], v[228:231], v[172:175], v[136:139]
    s_waitcnt lgkmcnt(0)
    v_mfma_f32_16x16x32_bf16 v[140:143], v[156:159], v[160:163], v[140:143]
    ds_read_b64_tr_b16 v[168:169], v74 offset:8192
    ds_read_b64_tr_b16 v[170:171], v74 offset:12288
    v_mfma_f32_16x16x32_bf16 v[148:151], v[160:163], v[160:163], v[148:151]
    ds_read_b64_tr_b16 v[172:173], v75 offset:8192
    ds_read_b64_tr_b16 v[174:175], v75 offset:12288
    v_mfma_f32_16x16x32_bf16 v[144:147], v[156:159], v[164:167], v[144:147]
    v_add_u32 v5, 4096, v5
    buffer_load_dwordx4 a[192:195], v5, s[8:11], s34 offen offset:0 sc1
    v_mfma_f32_16x16x32_bf16 v[152:155], v[164:167], v[164:167], v[152:155]
    ds_read_b64_tr_b16 v[204:205], v80 offset:35840
    ds_read_b64_tr_b16 v[206:207], v80 offset:39424
    v_mfma_f32_16x16x32_bf16 v[84:87], v[176:179], v[160:163], v[84:87]
    ds_read_b64_tr_b16 v[208:209], v80 offset:35872
    ds_read_b64_tr_b16 v[210:211], v80 offset:39456
    v_mfma_f32_16x16x32_bf16 v[88:91], v[176:179], v[164:167], v[88:91]
    ds_read_b64_tr_b16 v[212:213], v80 offset:35904
    ds_read_b64_tr_b16 v[214:215], v80 offset:39488
    v_mfma_f32_16x16x32_bf16 v[92:95], v[180:183], v[160:163], v[92:95]
    buffer_load_dwordx4 a[196:199], v5, s[8:11], s34 offen offset:1024 sc1
    v_mfma_f32_16x16x32_bf16 v[96:99], v[180:183], v[164:167], v[96:99]
    ds_read_b64_tr_b16 v[216:217], v80 offset:35936
    v_mfma_f32_16x16x32_bf16 v[100:103], v[184:187], v[160:163], v[100:103]
    ds_read_b64_tr_b16 v[218:219], v80 offset:39520
    v_mfma_f32_16x16x32_bf16 v[104:107], v[184:187], v[164:167], v[104:107]
    ds_read_b64_tr_b16 v[220:221], v80 offset:35968
    v_mfma_f32_16x16x32_bf16 v[108:111], v[188:191], v[160:163], v[108:111]
    buffer_load_dwordx4 a[200:203], v5, s[8:11], s34 offen offset:2048 sc1
    v_mfma_f32_16x16x32_bf16 v[112:115], v[188:191], v[164:167], v[112:115]
    ds_read_b64_tr_b16 v[222:223], v80 offset:39552
    v_accvgpr_read_b32 v9, a79
    v_mfma_f32_16x16x32_bf16 v[116:119], v[192:195], v[160:163], v[116:119]
    ds_read_b64_tr_b16 v[224:225], v80 offset:36000
    v_bitop3_b32 v8, v8, v9, s50 bitop3:0x7e
    v_mfma_f32_16x16x32_bf16 v[120:123], v[192:195], v[164:167], v[120:123]
    ds_read_b64_tr_b16 v[226:227], v80 offset:39584
    v_or_b32 v7, v7, v8
    v_mfma_f32_16x16x32_bf16 v[124:127], v[196:199], v[160:163], v[124:127]
    buffer_load_dwordx4 a[204:207], v5, s[8:11], s34 offen offset:3072 sc1
    v_mfma_f32_16x16x32_bf16 v[128:131], v[196:199], v[164:167], v[128:131]
    ds_read_b64_tr_b16 v[228:229], v80 offset:36032
    v_mfma_f32_16x16x32_bf16 v[132:135], v[200:203], v[160:163], v[132:135]
    ds_read_b64_tr_b16 v[230:231], v80 offset:39616
    v_mfma_f32_16x16x32_bf16 v[136:139], v[200:203], v[164:167], v[136:139]
    s_waitcnt lgkmcnt(0)
    s_waitcnt vmcnt(10)
    s_barrier
    v_mfma_f32_16x16x32_bf16 v[140:143], v[156:159], v[168:171], v[140:143]
    ds_read_b64_tr_b16 v[160:161], v74 offset:16384
    ds_read_b64_tr_b16 v[162:163], v74 offset:20480
    v_mfma_f32_16x16x32_bf16 v[148:151], v[168:171], v[168:171], v[148:151]
    ds_read_b64_tr_b16 v[164:165], v75 offset:16384
    ds_read_b64_tr_b16 v[166:167], v75 offset:20480
    v_mfma_f32_16x16x32_bf16 v[144:147], v[156:159], v[172:175], v[144:147]
    v_add_u32 v5, 4096, v5
    buffer_load_dwordx4 a[208:211], v5, s[8:11], s34 offen offset:0 sc1
    v_mfma_f32_16x16x32_bf16 v[152:155], v[172:175], v[172:175], v[152:155]
    ds_read_b64_tr_b16 v[176:177], v80 offset:43008
    ds_read_b64_tr_b16 v[178:179], v80 offset:46592
    v_mfma_f32_16x16x32_bf16 v[84:87], v[204:207], v[168:171], v[84:87]
    ds_read_b64_tr_b16 v[180:181], v80 offset:43040
    ds_read_b64_tr_b16 v[182:183], v80 offset:46624
    v_mfma_f32_16x16x32_bf16 v[88:91], v[204:207], v[172:175], v[88:91]
    ds_read_b64_tr_b16 v[184:185], v80 offset:43072
    ds_read_b64_tr_b16 v[186:187], v80 offset:46656
    v_mfma_f32_16x16x32_bf16 v[92:95], v[208:211], v[168:171], v[92:95]
    buffer_load_dwordx4 a[212:215], v5, s[8:11], s34 offen offset:1024 sc1
    v_mfma_f32_16x16x32_bf16 v[96:99], v[208:211], v[172:175], v[96:99]
    ds_read_b64_tr_b16 v[188:189], v80 offset:43104
    v_mfma_f32_16x16x32_bf16 v[100:103], v[212:215], v[168:171], v[100:103]
    ds_read_b64_tr_b16 v[190:191], v80 offset:46688
    v_mfma_f32_16x16x32_bf16 v[104:107], v[212:215], v[172:175], v[104:107]
    ds_read_b64_tr_b16 v[192:193], v80 offset:43136
    v_mfma_f32_16x16x32_bf16 v[108:111], v[216:219], v[168:171], v[108:111]
    buffer_load_dwordx4 a[216:219], v5, s[8:11], s34 offen offset:2048 sc1
    v_mfma_f32_16x16x32_bf16 v[112:115], v[216:219], v[172:175], v[112:115]
    ds_read_b64_tr_b16 v[194:195], v80 offset:46720
    v_accvgpr_read_b32 v8, a83
    v_mfma_f32_16x16x32_bf16 v[116:119], v[220:223], v[168:171], v[116:119]
    ds_read_b64_tr_b16 v[196:197], v80 offset:43168
    v_accvgpr_read_b32 v9, a87
    v_mfma_f32_16x16x32_bf16 v[120:123], v[220:223], v[172:175], v[120:123]
    ds_read_b64_tr_b16 v[198:199], v80 offset:46752
    v_bitop3_b32 v8, v8, v9, s50 bitop3:0x7e
    v_mfma_f32_16x16x32_bf16 v[124:127], v[224:227], v[168:171], v[124:127]
    buffer_load_dwordx4 a[220:223], v5, s[8:11], s34 offen offset:3072 sc1
    v_mfma_f32_16x16x32_bf16 v[128:131], v[224:227], v[172:175], v[128:131]
    ds_read_b64_tr_b16 v[200:201], v80 offset:43200
    v_mfma_f32_16x16x32_bf16 v[132:135], v[228:231], v[168:171], v[132:135]
    ds_read_b64_tr_b16 v[202:203], v80 offset:46784
    v_mfma_f32_16x16x32_bf16 v[136:139], v[228:231], v[172:175], v[136:139]
    s_waitcnt lgkmcnt(0)
    v_mfma_f32_16x16x32_bf16 v[140:143], v[156:159], v[160:163], v[140:143]
    ds_read_b64_tr_b16 v[168:169], v74 offset:24576
    ds_read_b64_tr_b16 v[170:171], v74 offset:28672
    v_mfma_f32_16x16x32_bf16 v[148:151], v[160:163], v[160:163], v[148:151]
    ds_read_b64_tr_b16 v[172:173], v75 offset:24576
    ds_read_b64_tr_b16 v[174:175], v75 offset:28672
    v_mfma_f32_16x16x32_bf16 v[144:147], v[156:159], v[164:167], v[144:147]
    v_add_u32 v5, 4096, v5
    buffer_load_dwordx4 a[224:227], v5, s[8:11], s34 offen offset:0 sc1
    v_mfma_f32_16x16x32_bf16 v[152:155], v[164:167], v[164:167], v[152:155]
    ds_read_b64_tr_b16 v[204:205], v80 offset:50176
    ds_read_b64_tr_b16 v[206:207], v80 offset:53760
    v_mfma_f32_16x16x32_bf16 v[84:87], v[176:179], v[160:163], v[84:87]
    ds_read_b64_tr_b16 v[208:209], v80 offset:50208
    ds_read_b64_tr_b16 v[210:211], v80 offset:53792
    v_mfma_f32_16x16x32_bf16 v[88:91], v[176:179], v[164:167], v[88:91]
    ds_read_b64_tr_b16 v[212:213], v80 offset:50240
    ds_read_b64_tr_b16 v[214:215], v80 offset:53824
    v_mfma_f32_16x16x32_bf16 v[92:95], v[180:183], v[160:163], v[92:95]
    buffer_load_dwordx4 a[228:231], v5, s[8:11], s34 offen offset:1024 sc1
    v_mfma_f32_16x16x32_bf16 v[96:99], v[180:183], v[164:167], v[96:99]
    ds_read_b64_tr_b16 v[216:217], v80 offset:50272
    v_mfma_f32_16x16x32_bf16 v[100:103], v[184:187], v[160:163], v[100:103]
    ds_read_b64_tr_b16 v[218:219], v80 offset:53856
    v_mfma_f32_16x16x32_bf16 v[104:107], v[184:187], v[164:167], v[104:107]
    ds_read_b64_tr_b16 v[220:221], v80 offset:50304
    v_mfma_f32_16x16x32_bf16 v[108:111], v[188:191], v[160:163], v[108:111]
    buffer_load_dwordx4 a[232:235], v5, s[8:11], s34 offen offset:2048 sc1
    v_mfma_f32_16x16x32_bf16 v[112:115], v[188:191], v[164:167], v[112:115]
    ds_read_b64_tr_b16 v[222:223], v80 offset:53888
    v_or_b32 v7, v7, v8
    v_mfma_f32_16x16x32_bf16 v[116:119], v[192:195], v[160:163], v[116:119]
    ds_read_b64_tr_b16 v[224:225], v80 offset:50336
    v_accvgpr_read_b32 v8, a91
    v_mfma_f32_16x16x32_bf16 v[120:123], v[192:195], v[164:167], v[120:123]
    ds_read_b64_tr_b16 v[226:227], v80 offset:53920
    v_accvgpr_read_b32 v9, a95
    v_mfma_f32_16x16x32_bf16 v[124:127], v[196:199], v[160:163], v[124:127]
    buffer_load_dwordx4 a[236:239], v5, s[8:11], s34 offen offset:3072 sc1
    v_mfma_f32_16x16x32_bf16 v[128:131], v[196:199], v[164:167], v[128:131]
    ds_read_b64_tr_b16 v[228:229], v80 offset:50368
    v_mfma_f32_16x16x32_bf16 v[132:135], v[200:203], v[160:163], v[132:135]
    ds_read_b64_tr_b16 v[230:231], v80 offset:53952
    v_mfma_f32_16x16x32_bf16 v[136:139], v[200:203], v[164:167], v[136:139]
    s_waitcnt lgkmcnt(0)
    v_mfma_f32_16x16x32_bf16 v[140:143], v[156:159], v[168:171], v[140:143]
    v_bitop3_b32 v8, v8, v9, s50 bitop3:0x7e
    v_mfma_f32_16x16x32_bf16 v[148:151], v[168:171], v[168:171], v[148:151]
    v_or_b32 v7, v7, v8
    v_mfma_f32_16x16x32_bf16 v[144:147], v[156:159], v[172:175], v[144:147]
    v_add_u32 v5, 4096, v5
    buffer_load_dwordx4 a[240:243], v5, s[8:11], s34 offen offset:0 sc1
    v_mfma_f32_16x16x32_bf16 v[152:155], v[172:175], v[172:175], v[152:155]
    v_mfma_f32_16x16x32_bf16 v[84:87], v[204:207], v[168:171], v[84:87]
    v_mfma_f32_16x16x32_bf16 v[88:91], v[204:207], v[172:175], v[88:91]
    s_mov_b32 s24, 0xffff0000
    s_mov_b32 s25, 0x3b000000
    s_mov_b32 s26, 0x3727c5ac
    v_cmp_eq_u32 vcc, 1, v235
    s_nop 1
    v_cndmask_b32 v148, v148, v149, vcc
    v_cndmask_b32 v152, v152, v153, vcc
    v_cmp_eq_u32 vcc, 2, v235
    s_nop 1
    v_cndmask_b32 v148, v148, v150, vcc
    v_cndmask_b32 v152, v152, v154, vcc
    v_cmp_eq_u32 vcc, 3, v235
    s_nop 1
    v_cndmask_b32 v148, v148, v151, vcc
    v_cndmask_b32 v152, v152, v155, vcc
    ds_bpermute_b32 v149, v244, v148
    ds_bpermute_b32 v153, v244, v152
    v_mfma_f32_16x16x32_bf16 v[92:95], v[208:211], v[168:171], v[92:95]
    v_mul_f32 v140, s25, v140
    v_mul_f32 v144, s25, v144
    v_cvt_pk_bf16_f32 v141, v140, v140
    v_and_b32 v141, s24, v141
    v_cvt_pk_bf16_f32 v145, v144, v144
    v_and_b32 v145, s24, v145
    buffer_load_dwordx4 a[244:247], v5, s[8:11], s34 offen offset:1024 sc1
    v_mfma_f32_16x16x32_bf16 v[96:99], v[208:211], v[172:175], v[96:99]
    v_mfma_f32_16x16x32_bf16 v[100:103], v[212:215], v[168:171], v[100:103]
    v_mfma_f32_16x16x32_bf16 v[104:107], v[212:215], v[172:175], v[104:107]
    v_mfma_f32_16x16x32_bf16 v[108:111], v[216:219], v[168:171], v[108:111]
    buffer_load_dwordx4 a[248:251], v5, s[8:11], s34 offen offset:2048 sc1
    v_mfma_f32_16x16x32_bf16 v[112:115], v[216:219], v[172:175], v[112:115]
    s_waitcnt lgkmcnt(0)
    v_mul_f32 v149, s25, v149
    v_mul_f32 v153, s25, v153
    v_fma_f32 v149, -v140, v140, v149
    v_fma_f32 v153, -v144, v144, v153
    v_mfma_f32_16x16x32_bf16 v[116:119], v[220:223], v[168:171], v[116:119]
    v_max_f32 v149, 0, v149
    v_max_f32 v153, 0, v153
    v_cvt_pk_bf16_f32 v149, v149, v149
    v_cvt_pk_bf16_f32 v153, v153, v153
    v_and_b32 v149, s24, v149
    v_mfma_f32_16x16x32_bf16 v[120:123], v[220:223], v[172:175], v[120:123]
    v_and_b32 v153, s24, v153
    v_add_f32 v149, s26, v149
    v_add_f32 v153, s26, v153
    v_cvt_pk_bf16_f32 v149, v149, v149
    v_cvt_pk_bf16_f32 v153, v153, v153
    v_mfma_f32_16x16x32_bf16 v[124:127], v[224:227], v[168:171], v[124:127]
    v_and_b32 v149, s24, v149
    v_and_b32 v153, s24, v153
    v_sqrt_f32 v149, v149
    v_sqrt_f32 v153, v153
    v_cvt_pk_bf16_f32 v149, v149, v149
    buffer_load_dwordx4 a[252:255], v5, s[8:11], s34 offen offset:3072 sc1
    v_mfma_f32_16x16x32_bf16 v[128:131], v[224:227], v[172:175], v[128:131]
    v_cvt_pk_bf16_f32 v153, v153, v153
    v_and_b32 v149, s24, v149
    v_and_b32 v153, s24, v153
    v_rcp_f32 v76, v149
    v_rcp_f32 v82, v153
    v_mfma_f32_16x16x32_bf16 v[132:135], v[228:231], v[168:171], v[132:135]
    v_mul_f32 v232, -v141, v76
    v_mul_f32 v250, -v145, v82
    v_mfma_f32_16x16x32_bf16 v[136:139], v[228:231], v[172:175], v[136:139]
    v_cmp_le_u32 vcc, 0x10000, v7
    s_cbranch_vccnz sequential_preLN__ssm_conv_s4d__dense_activation_gelu__prompt_kernel_w2s23
sequential_preLN__ssm_conv_s4d__dense_activation_gelu__prompt_kernel_w2b24:
    s_barrier
    v_mov_b32 v156, 0xc0135761
    v_mov_b32 v157, 0xc0135761
    v_mov_b32 v158, 1.0
    v_mov_b32 v159, 1.0
    v_pk_fma_f32 v[176:177], v[12:13], v[232:233], v[40:41] op_sel_hi:[1,0,1]
    v_pk_fma_f32 v[178:179], v[14:15], v[232:233], v[42:43] op_sel_hi:[1,0,1]
    v_pk_fma_f32 v[180:181], v[16:17], v[232:233], v[44:45] op_sel_hi:[1,0,1]
    v_pk_fma_f32 v[182:183], v[18:19], v[232:233], v[46:47] op_sel_hi:[1,0,1]
    v_pk_fma_f32 v[84:85], v[84:85], v[76:77], v[176:177] op_sel_hi:[1,0,1]
    v_pk_fma_f32 v[86:87], v[86:87], v[76:77], v[178:179] op_sel_hi:[1,0,1]
    v_pk_fma_f32 v[92:93], v[92:93], v[76:77], v[180:181] op_sel_hi:[1,0,1]
    v_pk_fma_f32 v[94:95], v[94:95], v[76:77], v[182:183] op_sel_hi:[1,0,1]
    v_pk_mul_f32 v[176:177], v[84:85], v[84:85]
    v_pk_mul_f32 v[178:179], v[86:87], v[86:87]
    v_pk_mul_f32 v[180:181], v[92:93], v[92:93]
    v_pk_mul_f32 v[182:183], v[94:95], v[94:95]
    v_pk_fma_f32 v[176:177], v[176:177], s[28:29], v[156:157]
    v_pk_fma_f32 v[178:179], v[178:179], s[28:29], v[156:157]
    v_pk_fma_f32 v[180:181], v[180:181], s[28:29], v[156:157]
    v_pk_fma_f32 v[182:183], v[182:183], s[28:29], v[156:157]
    v_pk_mul_f32 v[176:177], v[176:177], v[84:85]
    v_pk_mul_f32 v[178:179], v[178:179], v[86:87]
    v_pk_mul_f32 v[180:181], v[180:181], v[92:93]
    v_pk_mul_f32 v[182:183], v[182:183], v[94:95]
    v_exp_f32 v176, v176
    v_exp_f32 v177, v177
    v_exp_f32 v178, v178
    v_exp_f32 v179, v179
    v_exp_f32 v180, v180
    v_exp_f32 v181, v181
    v_exp_f32 v182, v182
    v_exp_f32 v183, v183
    v_pk_add_f32 v[176:177], v[176:177], v[158:159]
    v_pk_add_f32 v[178:179], v[178:179], v[158:159]
    v_pk_add_f32 v[180:181], v[180:181], v[158:159]
    v_pk_add_f32 v[182:183], v[182:183], v[158:159]
    v_rcp_f32 v176, v176
    v_rcp_f32 v177, v177
    v_rcp_f32 v178, v178
    v_rcp_f32 v179, v179
    v_rcp_f32 v180, v180
    v_rcp_f32 v181, v181
    v_rcp_f32 v182, v182
    v_rcp_f32 v183, v183
    v_pk_mul_f32 v[84:85], v[84:85], v[176:177]
    v_pk_mul_f32 v[86:87], v[86:87], v[178:179]
    v_pk_mul_f32 v[92:93], v[92:93], v[180:181]
    v_pk_mul_f32 v[94:95], v[94:95], v[182:183]
    v_cvt_pk_bf16_f32 v160, v84, v85
    v_cvt_pk_bf16_f32 v161, v86, v87
    v_cvt_pk_bf16_f32 v162, v92, v93
    v_cvt_pk_bf16_f32 v163, v94, s50
    s_add_u32 s46, s30, 0
    buffer_store_dwordx4 v[160:163], v2, s[8:11], s46 offen sc1
    v_pk_fma_f32 v[176:177], v[12:13], v[250:251], v[40:41] op_sel_hi:[1,0,1]
    v_pk_fma_f32 v[178:179], v[14:15], v[250:251], v[42:43] op_sel_hi:[1,0,1]
    v_pk_fma_f32 v[180:181], v[16:17], v[250:251], v[44:45] op_sel_hi:[1,0,1]
    v_pk_fma_f32 v[182:183], v[18:19], v[250:251], v[46:47] op_sel_hi:[1,0,1]
    v_pk_fma_f32 v[88:89], v[88:89], v[82:83], v[176:177] op_sel_hi:[1,0,1]
    v_pk_fma_f32 v[90:91], v[90:91], v[82:83], v[178:179] op_sel_hi:[1,0,1]
    v_pk_fma_f32 v[96:97], v[96:97], v[82:83], v[180:181] op_sel_hi:[1,0,1]
    v_pk_fma_f32 v[98:99], v[98:99], v[82:83], v[182:183] op_sel_hi:[1,0,1]
    v_pk_mul_f32 v[176:177], v[88:89], v[88:89]
    v_pk_mul_f32 v[178:179], v[90:91], v[90:91]
    v_pk_mul_f32 v[180:181], v[96:97], v[96:97]
    v_pk_mul_f32 v[182:183], v[98:99], v[98:99]
    v_pk_fma_f32 v[176:177], v[176:177], s[28:29], v[156:157]
    v_pk_fma_f32 v[178:179], v[178:179], s[28:29], v[156:157]
    v_pk_fma_f32 v[180:181], v[180:181], s[28:29], v[156:157]
    v_pk_fma_f32 v[182:183], v[182:183], s[28:29], v[156:157]
    v_pk_mul_f32 v[176:177], v[176:177], v[88:89]
    v_pk_mul_f32 v[178:179], v[178:179], v[90:91]
    v_pk_mul_f32 v[180:181], v[180:181], v[96:97]
    v_pk_mul_f32 v[182:183], v[182:183], v[98:99]
    v_exp_f32 v176, v176
    v_exp_f32 v177, v177
    v_exp_f32 v178, v178
    v_exp_f32 v179, v179
    v_exp_f32 v180, v180
    v_exp_f32 v181, v181
    v_exp_f32 v182, v182
    v_exp_f32 v183, v183
    v_pk_add_f32 v[176:177], v[176:177], v[158:159]
    v_pk_add_f32 v[178:179], v[178:179], v[158:159]
    v_pk_add_f32 v[180:181], v[180:181], v[158:159]
    v_pk_add_f32 v[182:183], v[182:183], v[158:159]
    v_rcp_f32 v176, v176
    v_rcp_f32 v177, v177
    v_rcp_f32 v178, v178
    v_rcp_f32 v179, v179
    v_rcp_f32 v180, v180
    v_rcp_f32 v181, v181
    v_rcp_f32 v182, v182
    v_rcp_f32 v183, v183
    v_pk_mul_f32 v[88:89], v[88:89], v[176:177]
    v_pk_mul_f32 v[90:91], v[90:91], v[178:179]
    v_pk_mul_f32 v[96:97], v[96:97], v[180:181]
    v_pk_mul_f32 v[98:99], v[98:99], v[182:183]
    v_cvt_pk_bf16_f32 v164, v88, v89
    v_cvt_pk_bf16_f32 v165, v90, v91
    v_cvt_pk_bf16_f32 v166, v96, v97
    v_cvt_pk_bf16_f32 v167, v98, s50
    s_add_u32 s46, s30, 1024
    buffer_store_dwordx4 v[164:167], v2, s[8:11], s46 offen sc1
    v_pk_fma_f32 v[176:177], v[20:21], v[232:233], v[48:49] op_sel_hi:[1,0,1]
    v_pk_fma_f32 v[178:179], v[22:23], v[232:233], v[50:51] op_sel_hi:[1,0,1]
    v_pk_fma_f32 v[180:181], v[24:25], v[232:233], v[52:53] op_sel_hi:[1,0,1]
    v_pk_fma_f32 v[182:183], v[26:27], v[232:233], v[54:55] op_sel_hi:[1,0,1]
    v_pk_fma_f32 v[100:101], v[100:101], v[76:77], v[176:177] op_sel_hi:[1,0,1]
    v_pk_fma_f32 v[102:103], v[102:103], v[76:77], v[178:179] op_sel_hi:[1,0,1]
    v_pk_fma_f32 v[108:109], v[108:109], v[76:77], v[180:181] op_sel_hi:[1,0,1]
    v_pk_fma_f32 v[110:111], v[110:111], v[76:77], v[182:183] op_sel_hi:[1,0,1]
    v_pk_mul_f32 v[176:177], v[100:101], v[100:101]
    v_pk_mul_f32 v[178:179], v[102:103], v[102:103]
    v_pk_mul_f32 v[180:181], v[108:109], v[108:109]
    v_pk_mul_f32 v[182:183], v[110:111], v[110:111]
    v_pk_fma_f32 v[176:177], v[176:177], s[28:29], v[156:157]
    v_pk_fma_f32 v[178:179], v[178:179], s[28:29], v[156:157]
    v_pk_fma_f32 v[180:181], v[180:181], s[28:29], v[156:157]
    v_pk_fma_f32 v[182:183], v[182:183], s[28:29], v[156:157]
    v_pk_mul_f32 v[176:177], v[176:177], v[100:101]
    v_pk_mul_f32 v[178:179], v[178:179], v[102:103]
    v_pk_mul_f32 v[180:181], v[180:181], v[108:109]
    v_pk_mul_f32 v[182:183], v[182:183], v[110:111]
    v_exp_f32 v176, v176
    v_exp_f32 v177, v177
    v_exp_f32 v178, v178
    v_exp_f32 v179, v179
    v_exp_f32 v180, v180
    v_exp_f32 v181, v181
    v_exp_f32 v182, v182
    v_exp_f32 v183, v183
    v_pk_add_f32 v[176:177], v[176:177], v[158:159]
    v_pk_add_f32 v[178:179], v[178:179], v[158:159]
    v_pk_add_f32 v[180:181], v[180:181], v[158:159]
    v_pk_add_f32 v[182:183], v[182:183], v[158:159]
    v_rcp_f32 v176, v176
    v_rcp_f32 v177, v177
    v_rcp_f32 v178, v178
    v_rcp_f32 v179, v179
    v_rcp_f32 v180, v180
    v_rcp_f32 v181, v181
    v_rcp_f32 v182, v182
    v_rcp_f32 v183, v183
    v_pk_mul_f32 v[100:101], v[100:101], v[176:177]
    v_pk_mul_f32 v[102:103], v[102:103], v[178:179]
    v_pk_mul_f32 v[108:109], v[108:109], v[180:181]
    v_pk_mul_f32 v[110:111], v[110:111], v[182:183]
    v_cvt_pk_bf16_f32 v168, v100, v101
    v_cvt_pk_bf16_f32 v169, v102, v103
    v_cvt_pk_bf16_f32 v170, v108, v109
    v_cvt_pk_bf16_f32 v171, v110, s50
    s_add_u32 s46, s30, 4096
    buffer_store_dwordx4 v[168:171], v2, s[8:11], s46 offen sc1
    v_pk_fma_f32 v[176:177], v[20:21], v[250:251], v[48:49] op_sel_hi:[1,0,1]
    v_pk_fma_f32 v[178:179], v[22:23], v[250:251], v[50:51] op_sel_hi:[1,0,1]
    v_pk_fma_f32 v[180:181], v[24:25], v[250:251], v[52:53] op_sel_hi:[1,0,1]
    v_pk_fma_f32 v[182:183], v[26:27], v[250:251], v[54:55] op_sel_hi:[1,0,1]
    v_pk_fma_f32 v[104:105], v[104:105], v[82:83], v[176:177] op_sel_hi:[1,0,1]
    v_pk_fma_f32 v[106:107], v[106:107], v[82:83], v[178:179] op_sel_hi:[1,0,1]
    v_pk_fma_f32 v[112:113], v[112:113], v[82:83], v[180:181] op_sel_hi:[1,0,1]
    v_pk_fma_f32 v[114:115], v[114:115], v[82:83], v[182:183] op_sel_hi:[1,0,1]
    v_pk_mul_f32 v[176:177], v[104:105], v[104:105]
    v_pk_mul_f32 v[178:179], v[106:107], v[106:107]
    v_pk_mul_f32 v[180:181], v[112:113], v[112:113]
    v_pk_mul_f32 v[182:183], v[114:115], v[114:115]
    v_pk_fma_f32 v[176:177], v[176:177], s[28:29], v[156:157]
    v_pk_fma_f32 v[178:179], v[178:179], s[28:29], v[156:157]
    v_pk_fma_f32 v[180:181], v[180:181], s[28:29], v[156:157]
    v_pk_fma_f32 v[182:183], v[182:183], s[28:29], v[156:157]
    v_pk_mul_f32 v[176:177], v[176:177], v[104:105]
    v_pk_mul_f32 v[178:179], v[178:179], v[106:107]
    v_pk_mul_f32 v[180:181], v[180:181], v[112:113]
    v_pk_mul_f32 v[182:183], v[182:183], v[114:115]
    v_exp_f32 v176, v176
    v_exp_f32 v177, v177
    v_exp_f32 v178, v178
    v_exp_f32 v179, v179
    v_exp_f32 v180, v180
    v_exp_f32 v181, v181
    v_exp_f32 v182, v182
    v_exp_f32 v183, v183
    v_pk_add_f32 v[176:177], v[176:177], v[158:159]
    v_pk_add_f32 v[178:179], v[178:179], v[158:159]
    v_pk_add_f32 v[180:181], v[180:181], v[158:159]
    v_pk_add_f32 v[182:183], v[182:183], v[158:159]
    v_rcp_f32 v176, v176
    v_rcp_f32 v177, v177
    v_rcp_f32 v178, v178
    v_rcp_f32 v179, v179
    v_rcp_f32 v180, v180
    v_rcp_f32 v181, v181
    v_rcp_f32 v182, v182
    v_rcp_f32 v183, v183
    v_pk_mul_f32 v[104:105], v[104:105], v[176:177]
    v_pk_mul_f32 v[106:107], v[106:107], v[178:179]
    v_pk_mul_f32 v[112:113], v[112:113], v[180:181]
    v_pk_mul_f32 v[114:115], v[114:115], v[182:183]
    v_cvt_pk_bf16_f32 v172, v104, v105
    v_cvt_pk_bf16_f32 v173, v106, v107
    v_cvt_pk_bf16_f32 v174, v112, v113
    v_cvt_pk_bf16_f32 v175, v114, s50
    s_add_u32 s46, s30, 5120
    buffer_store_dwordx4 v[172:175], v2, s[8:11], s46 offen sc1
    v_pk_fma_f32 v[176:177], v[28:29], v[232:233], v[56:57] op_sel_hi:[1,0,1]
    v_pk_fma_f32 v[178:179], v[30:31], v[232:233], v[58:59] op_sel_hi:[1,0,1]
    v_pk_fma_f32 v[180:181], v[32:33], v[232:233], v[60:61] op_sel_hi:[1,0,1]
    v_pk_fma_f32 v[182:183], v[34:35], v[232:233], v[62:63] op_sel_hi:[1,0,1]
    v_pk_fma_f32 v[116:117], v[116:117], v[76:77], v[176:177] op_sel_hi:[1,0,1]
    v_pk_fma_f32 v[118:119], v[118:119], v[76:77], v[178:179] op_sel_hi:[1,0,1]
    v_pk_fma_f32 v[124:125], v[124:125], v[76:77], v[180:181] op_sel_hi:[1,0,1]
    v_pk_fma_f32 v[126:127], v[126:127], v[76:77], v[182:183] op_sel_hi:[1,0,1]
    v_pk_mul_f32 v[176:177], v[116:117], v[116:117]
    v_pk_mul_f32 v[178:179], v[118:119], v[118:119]
    v_pk_mul_f32 v[180:181], v[124:125], v[124:125]
    v_pk_mul_f32 v[182:183], v[126:127], v[126:127]
    v_pk_fma_f32 v[176:177], v[176:177], s[28:29], v[156:157]
    v_pk_fma_f32 v[178:179], v[178:179], s[28:29], v[156:157]
    v_pk_fma_f32 v[180:181], v[180:181], s[28:29], v[156:157]
    v_pk_fma_f32 v[182:183], v[182:183], s[28:29], v[156:157]
    v_pk_mul_f32 v[176:177], v[176:177], v[116:117]
    v_pk_mul_f32 v[178:179], v[178:179], v[118:119]
    v_pk_mul_f32 v[180:181], v[180:181], v[124:125]
    v_pk_mul_f32 v[182:183], v[182:183], v[126:127]
    v_exp_f32 v176, v176
    v_exp_f32 v177, v177
    v_exp_f32 v178, v178
    v_exp_f32 v179, v179
    v_exp_f32 v180, v180
    v_exp_f32 v181, v181
    v_exp_f32 v182, v182
    v_exp_f32 v183, v183
    v_pk_add_f32 v[176:177], v[176:177], v[158:159]
    v_pk_add_f32 v[178:179], v[178:179], v[158:159]
    v_pk_add_f32 v[180:181], v[180:181], v[158:159]
    v_pk_add_f32 v[182:183], v[182:183], v[158:159]
    v_rcp_f32 v176, v176
    v_rcp_f32 v177, v177
    v_rcp_f32 v178, v178
    v_rcp_f32 v179, v179
    v_rcp_f32 v180, v180
    v_rcp_f32 v181, v181
    v_rcp_f32 v182, v182
    v_rcp_f32 v183, v183
    v_pk_mul_f32 v[116:117], v[116:117], v[176:177]
    v_pk_mul_f32 v[118:119], v[118:119], v[178:179]
    v_pk_mul_f32 v[124:125], v[124:125], v[180:181]
    v_pk_mul_f32 v[126:127], v[126:127], v[182:183]
    v_cvt_pk_bf16_f32 v160, v116, v117
    v_cvt_pk_bf16_f32 v161, v118, v119
    v_cvt_pk_bf16_f32 v162, v124, v125
    v_cvt_pk_bf16_f32 v163, v126, s50
    s_add_u32 s46, s30, 8192
    buffer_store_dwordx4 v[160:163], v2, s[8:11], s46 offen sc1
    v_pk_fma_f32 v[176:177], v[28:29], v[250:251], v[56:57] op_sel_hi:[1,0,1]
    v_pk_fma_f32 v[178:179], v[30:31], v[250:251], v[58:59] op_sel_hi:[1,0,1]
    v_pk_fma_f32 v[180:181], v[32:33], v[250:251], v[60:61] op_sel_hi:[1,0,1]
    v_pk_fma_f32 v[182:183], v[34:35], v[250:251], v[62:63] op_sel_hi:[1,0,1]
    v_pk_fma_f32 v[120:121], v[120:121], v[82:83], v[176:177] op_sel_hi:[1,0,1]
    v_pk_fma_f32 v[122:123], v[122:123], v[82:83], v[178:179] op_sel_hi:[1,0,1]
    v_pk_fma_f32 v[128:129], v[128:129], v[82:83], v[180:181] op_sel_hi:[1,0,1]
    v_pk_fma_f32 v[130:131], v[130:131], v[82:83], v[182:183] op_sel_hi:[1,0,1]
    v_pk_mul_f32 v[176:177], v[120:121], v[120:121]
    v_pk_mul_f32 v[178:179], v[122:123], v[122:123]
    v_pk_mul_f32 v[180:181], v[128:129], v[128:129]
    v_pk_mul_f32 v[182:183], v[130:131], v[130:131]
    v_pk_fma_f32 v[176:177], v[176:177], s[28:29], v[156:157]
    v_pk_fma_f32 v[178:179], v[178:179], s[28:29], v[156:157]
    v_pk_fma_f32 v[180:181], v[180:181], s[28:29], v[156:157]
    v_pk_fma_f32 v[182:183], v[182:183], s[28:29], v[156:157]
    v_pk_mul_f32 v[176:177], v[176:177], v[120:121]
    v_pk_mul_f32 v[178:179], v[178:179], v[122:123]
    v_pk_mul_f32 v[180:181], v[180:181], v[128:129]
    v_pk_mul_f32 v[182:183], v[182:183], v[130:131]
    v_exp_f32 v176, v176
    v_exp_f32 v177, v177
    v_exp_f32 v178, v178
    v_exp_f32 v179, v179
    v_exp_f32 v180, v180
    v_exp_f32 v181, v181
    v_exp_f32 v182, v182
    v_exp_f32 v183, v183
    v_pk_add_f32 v[176:177], v[176:177], v[158:159]
    v_pk_add_f32 v[178:179], v[178:179], v[158:159]
    v_pk_add_f32 v[180:181], v[180:181], v[158:159]
    v_pk_add_f32 v[182:183], v[182:183], v[158:159]
    v_rcp_f32 v176, v176
    v_rcp_f32 v177, v177
    v_rcp_f32 v178, v178
    v_rcp_f32 v179, v179
    v_rcp_f32 v180, v180
    v_rcp_f32 v181, v181
    v_rcp_f32 v182, v182
    v_rcp_f32 v183, v183
    v_pk_mul_f32 v[120:121], v[120:121], v[176:177]
    v_pk_mul_f32 v[122:123], v[122:123], v[178:179]
    v_pk_mul_f32 v[128:129], v[128:129], v[180:181]
    v_pk_mul_f32 v[130:131], v[130:131], v[182:183]
    v_cvt_pk_bf16_f32 v164, v120, v121
    v_cvt_pk_bf16_f32 v165, v122, v123
    v_cvt_pk_bf16_f32 v166, v128, v129
    v_cvt_pk_bf16_f32 v167, v130, s50
    s_add_u32 s46, s30, 9216
    buffer_store_dwordx4 v[164:167], v2, s[8:11], s46 offen sc1
    v_pk_fma_f32 v[176:177], v[36:37], v[232:233], v[64:65] op_sel_hi:[1,0,1]
    v_pk_fma_f32 v[178:179], v[38:39], v[232:233], v[66:67] op_sel_hi:[1,0,1]
    v_pk_fma_f32 v[180:181], v[36:37], v[250:251], v[64:65] op_sel_hi:[1,0,1]
    v_pk_fma_f32 v[182:183], v[38:39], v[250:251], v[66:67] op_sel_hi:[1,0,1]
    s_add_u32 s39, s38, 0
    buffer_load_dwordx4 v[12:15], v246, s[8:11], s39 offen sc1
    v_pk_fma_f32 v[132:133], v[132:133], v[76:77], v[176:177] op_sel_hi:[1,0,1]
    v_pk_fma_f32 v[134:135], v[134:135], v[76:77], v[178:179] op_sel_hi:[1,0,1]
    v_pk_fma_f32 v[136:137], v[136:137], v[82:83], v[180:181] op_sel_hi:[1,0,1]
    v_pk_fma_f32 v[138:139], v[138:139], v[82:83], v[182:183] op_sel_hi:[1,0,1]
    buffer_load_dwordx4 v[16:19], v247, s[8:11], s39 offen sc1
    v_pk_mul_f32 v[176:177], v[132:133], v[132:133]
    v_pk_mul_f32 v[178:179], v[134:135], v[134:135]
    v_pk_mul_f32 v[180:181], v[136:137], v[136:137]
    v_pk_mul_f32 v[182:183], v[138:139], v[138:139]
    buffer_load_dwordx4 v[20:23], v248, s[8:11], s39 offen sc1
    v_pk_fma_f32 v[176:177], v[176:177], s[28:29], v[156:157]
    v_pk_fma_f32 v[178:179], v[178:179], s[28:29], v[156:157]
    v_pk_fma_f32 v[180:181], v[180:181], s[28:29], v[156:157]
    v_pk_fma_f32 v[182:183], v[182:183], s[28:29], v[156:157]
    buffer_load_dwordx4 v[24:27], v249, s[8:11], s39 offen sc1
    v_pk_mul_f32 v[176:177], v[176:177], v[132:133]
    v_pk_mul_f32 v[178:179], v[178:179], v[134:135]
    v_pk_mul_f32 v[180:181], v[180:181], v[136:137]
    v_pk_mul_f32 v[182:183], v[182:183], v[138:139]
    s_add_u32 s39, s38, 16384
    buffer_load_dwordx4 v[28:31], v246, s[8:11], s39 offen sc1
    v_exp_f32 v176, v176
    v_exp_f32 v177, v177
    v_exp_f32 v178, v178
    v_exp_f32 v179, v179
    v_exp_f32 v180, v180
    v_exp_f32 v181, v181
    v_exp_f32 v182, v182
    v_exp_f32 v183, v183
    buffer_load_dwordx4 v[32:35], v247, s[8:11], s39 offen sc1
    v_pk_add_f32 v[176:177], v[176:177], v[158:159]
    v_pk_add_f32 v[178:179], v[178:179], v[158:159]
    v_pk_add_f32 v[180:181], v[180:181], v[158:159]
    v_pk_add_f32 v[182:183], v[182:183], v[158:159]
    buffer_load_dwordx4 v[40:43], v248, s[8:11], s39 offen sc1
    v_rcp_f32 v176, v176
    v_rcp_f32 v177, v177
    v_rcp_f32 v178, v178
    v_rcp_f32 v179, v179
    v_rcp_f32 v180, v180
    v_rcp_f32 v181, v181
    v_rcp_f32 v182, v182
    v_rcp_f32 v183, v183
    buffer_load_dwordx4 v[44:47], v249, s[8:11], s39 offen sc1
    v_pk_mul_f32 v[132:133], v[132:133], v[176:177]
    v_pk_mul_f32 v[134:135], v[134:135], v[178:179]
    v_pk_mul_f32 v[136:137], v[136:137], v[180:181]
    v_pk_mul_f32 v[138:139], v[138:139], v[182:183]
    v_cvt_pk_bf16_f32 v168, v132, v133
    v_cvt_pk_bf16_f32 v169, v134, v135
    v_cvt_pk_bf16_f32 v170, v95, v111
    v_cvt_pk_bf16_f32 v171, v127, s50
    s_add_u32 s46, s30, 12288
    buffer_store_dwordx4 v[168:171], v2, s[8:11], s46 offen sc1
    v_cvt_pk_bf16_f32 v172, v136, v137
    v_cvt_pk_bf16_f32 v173, v138, v139
    v_cvt_pk_bf16_f32 v174, v99, v115
    v_cvt_pk_bf16_f32 v175, v131, s50
    s_add_u32 s46, s30, 13312
    buffer_store_dwordx4 v[172:175], v2, s[8:11], s46 offen sc1
    s_add_u32 s39, s38, 32768
    buffer_load_dwordx4 v[48:51], v246, s[8:11], s39 offen sc1
    buffer_load_dwordx4 v[52:55], v247, s[8:11], s39 offen sc1
    buffer_load_dwordx4 v[56:59], v248, s[8:11], s39 offen sc1
    buffer_load_dwordx4 v[60:63], v249, s[8:11], s39 offen sc1
    s_add_u32 s39, s38, 49152
    buffer_load_dwordx4 v[84:87], v246, s[8:11], s39 offen sc1
    buffer_load_dwordx4 v[88:91], v247, s[8:11], s39 offen sc1
    buffer_load_dwordx4 v[100:103], v248, s[8:11], s39 offen sc1
    buffer_load_dwordx4 v[104:107], v249, s[8:11], s39 offen sc1
    s_waitcnt vmcnt(14)
    v_bitop3_b32 v78, v15, v19, s50 bitop3:0x7e
    v_bitop3_b32 v81, v23, v27, s50 bitop3:0x7e
    v_or_b32 v78, v78, v81
    v_cmp_le_u32 vcc, 0x10000, v78
    s_cbranch_vccnz sequential_preLN__ssm_conv_s4d__dense_activation_gelu__prompt_kernel_slow25
sequential_preLN__ssm_conv_s4d__dense_activation_gelu__prompt_kernel_back26:
    v_mfma_f32_16x16x32_bf16 v[92:95], a[0:3], v[12:15], 0
    s_add_u32 s39, s38, 4096
    buffer_load_dwordx4 v[36:39], v246, s[8:11], s39 offen sc1
    v_mfma_f32_16x16x32_bf16 v[96:99], a[0:3], v[16:19], 0
    v_mfma_f32_16x16x32_bf16 v[108:111], a[0:3], v[20:23], 0
    v_mfma_f32_16x16x32_bf16 v[112:115], a[0:3], v[24:27], 0
    buffer_load_dwordx4 v[64:67], v247, s[8:11], s39 offen sc1
    v_mfma_f32_16x16x32_bf16 v[116:119], a[4:7], v[12:15], 0
    v_mfma_f32_16x16x32_bf16 v[120:123], a[4:7], v[16:19], 0
    v_mfma_f32_16x16x32_bf16 v[124:127], a[4:7], v[20:23], 0
    buffer_load_dwordx4 v[68:71], v248, s[8:11], s39 offen sc1
    v_mfma_f32_16x16x32_bf16 v[128:131], a[4:7], v[24:27], 0
    v_mfma_f32_16x16x32_bf16 v[132:135], a[8:11], v[12:15], 0
    v_mfma_f32_16x16x32_bf16 v[136:139], a[8:11], v[16:19], 0
    buffer_load_dwordx4 v[72:75], v249, s[8:11], s39 offen sc1
    v_mfma_f32_16x16x32_bf16 v[140:143], a[8:11], v[20:23], 0
    v_mfma_f32_16x16x32_bf16 v[144:147], a[8:11], v[24:27], 0
    s_waitcnt vmcnt(14)
    v_bitop3_b32 v78, v31, v35, s50 bitop3:0x7e
    v_mfma_f32_16x16x32_bf16 v[148:151], a[12:15], v[12:15], 0
    v_bitop3_b32 v81, v43, v47, s50 bitop3:0x7e
    v_mfma_f32_16x16x32_bf16 v[152:155], a[12:15], v[16:19], 0
    v_or_b32 v78, v78, v81
    v_mfma_f32_16x16x32_bf16 v[156:159], a[12:15], v[20:23], 0
    v_cmp_le_u32 vcc, 0x10000, v78
    v_mfma_f32_16x16x32_bf16 v[160:163], a[12:15], v[24:27], 0
    s_cbranch_vccnz sequential_preLN__ssm_conv_s4d__dense_activation_gelu__prompt_kernel_slow27
sequential_preLN__ssm_conv_s4d__dense_activation_gelu__prompt_kernel_back28:
    v_mfma_f32_16x16x32_bf16 v[92:95], a[64:67], v[28:31], v[92:95]
    s_add_u32 s39, s38, 20480
    buffer_load_dwordx4 v[12:15], v246, s[8:11], s39 offen sc1
    v_mfma_f32_16x16x32_bf16 v[96:99], a[64:67], v[32:35], v[96:99]
    s_lshl_b32 s29, s20, 11
    v_mfma_f32_16x16x32_bf16 v[108:111], a[64:67], v[40:43], v[108:111]
    s_add_u32 s29, s29, 147456
    v_mfma_f32_16x16x32_bf16 v[112:115], a[64:67], v[44:47], v[112:115]
    buffer_load_dwordx4 v[16:19], v247, s[8:11], s39 offen sc1
    v_mfma_f32_16x16x32_bf16 v[116:119], a[68:71], v[28:31], v[116:119]
    v_add_u32 v80, s29, v245
    v_mfma_f32_16x16x32_bf16 v[120:123], a[68:71], v[32:35], v[120:123]
    s_mul_i32 s27, s43, 12
    v_mfma_f32_16x16x32_bf16 v[124:127], a[68:71], v[40:43], v[124:127]
    buffer_load_dwordx4 v[20:23], v248, s[8:11], s39 offen sc1
    v_mfma_f32_16x16x32_bf16 v[128:131], a[68:71], v[44:47], v[128:131]
    s_add_u32 s27, s27, 0
    v_mfma_f32_16x16x32_bf16 v[132:135], a[72:75], v[28:31], v[132:135]
    v_add_u32 v11, s27, v2
    v_mfma_f32_16x16x32_bf16 v[136:139], a[72:75], v[32:35], v[136:139]
    buffer_load_dwordx4 v[24:27], v249, s[8:11], s39 offen sc1
    v_mfma_f32_16x16x32_bf16 v[140:143], a[72:75], v[40:43], v[140:143]
    s_mul_i32 s27, s44, 12
    v_mfma_f32_16x16x32_bf16 v[144:147], a[72:75], v[44:47], v[144:147]
    s_waitcnt vmcnt(12)
    v_bitop3_b32 v78, v51, v55, s50 bitop3:0x7e
    v_mfma_f32_16x16x32_bf16 v[148:151], a[76:79], v[28:31], v[148:151]
    v_bitop3_b32 v81, v59, v63, s50 bitop3:0x7e
    v_mfma_f32_16x16x32_bf16 v[152:155], a[76:79], v[32:35], v[152:155]
    v_or_b32 v78, v78, v81
    v_mfma_f32_16x16x32_bf16 v[156:159], a[76:79], v[40:43], v[156:159]
    v_cmp_le_u32 vcc, 0x10000, v78
    v_mfma_f32_16x16x32_bf16 v[160:163], a[76:79], v[44:47], v[160:163]
    s_cbranch_vccnz sequential_preLN__ssm_conv_s4d__dense_activation_gelu__prompt_kernel_slow29
sequential_preLN__ssm_conv_s4d__dense_activation_gelu__prompt_kernel_back30:
    v_mfma_f32_16x16x32_bf16 v[92:95], a[128:131], v[48:51], v[92:95]
    s_add_u32 s39, s38, 36864
    buffer_load_dwordx4 v[28:31], v246, s[8:11], s39 offen sc1
    v_mfma_f32_16x16x32_bf16 v[96:99], a[128:131], v[52:55], v[96:99]
    s_add_u32 s27, s27, 4096
    v_mfma_f32_16x16x32_bf16 v[108:111], a[128:131], v[56:59], v[108:111]
    v_add_u32 v76, s27, v2
    v_mfma_f32_16x16x32_bf16 v[112:115], a[128:131], v[60:63], v[112:115]
    buffer_load_dwordx4 v[32:35], v247, s[8:11], s39 offen sc1
    v_mfma_f32_16x16x32_bf16 v[116:119], a[132:135], v[48:51], v[116:119]
    s_mul_i32 s27, s45, 12
    v_mfma_f32_16x16x32_bf16 v[120:123], a[132:135], v[52:55], v[120:123]
    s_add_u32 s27, s27, 8192
    v_mfma_f32_16x16x32_bf16 v[124:127], a[132:135], v[56:59], v[124:127]
    buffer_load_dwordx4 v[40:43], v248, s[8:11], s39 offen sc1
    v_mfma_f32_16x16x32_bf16 v[128:131], a[132:135], v[60:63], v[128:131]
    v_add_u32 v77, s27, v2
    v_mfma_f32_16x16x32_bf16 v[132:135], a[136:139], v[48:51], v[132:135]
    ds_read_b64_tr_b16 v[164:165], v80 offset:0
    v_mfma_f32_16x16x32_bf16 v[136:139], a[136:139], v[52:55], v[136:139]
    buffer_load_dwordx4 v[44:47], v249, s[8:11], s39 offen sc1
    v_mfma_f32_16x16x32_bf16 v[140:143], a[136:139], v[56:59], v[140:143]
    ds_read_b64_tr_b16 v[166:167], v80 offset:512
    v_mfma_f32_16x16x32_bf16 v[144:147], a[136:139], v[60:63], v[144:147]
    s_waitcnt vmcnt(12)
    v_bitop3_b32 v78, v87, v91, s50 bitop3:0x7e
    v_mfma_f32_16x16x32_bf16 v[148:151], a[140:143], v[48:51], v[148:151]
    v_bitop3_b32 v81, v103, v107, s50 bitop3:0x7e
    v_mfma_f32_16x16x32_bf16 v[152:155], a[140:143], v[52:55], v[152:155]
    v_or_b32 v78, v78, v81
    v_mfma_f32_16x16x32_bf16 v[156:159], a[140:143], v[56:59], v[156:159]
    v_cmp_le_u32 vcc, 0x10000, v78
    v_mfma_f32_16x16x32_bf16 v[160:163], a[140:143], v[60:63], v[160:163]
    s_cbranch_vccnz sequential_preLN__ssm_conv_s4d__dense_activation_gelu__prompt_kernel_slow31
sequential_preLN__ssm_conv_s4d__dense_activation_gelu__prompt_kernel_back32:
    v_mfma_f32_16x16x32_bf16 v[92:95], a[192:195], v[84:87], v[92:95]
    s_add_u32 s39, s38, 53248
    buffer_load_dwordx4 v[48:51], v246, s[8:11], s39 offen sc1
    v_mfma_f32_16x16x32_bf16 v[96:99], a[192:195], v[88:91], v[96:99]
    ds_read_b64_tr_b16 v[168:169], v80 offset:1024
    v_mfma_f32_16x16x32_bf16 v[108:111], a[192:195], v[100:103], v[108:111]
    ds_read_b64_tr_b16 v[170:171], v80 offset:1536
    v_mfma_f32_16x16x32_bf16 v[112:115], a[192:195], v[104:107], v[112:115]
    buffer_load_dwordx4 v[52:55], v247, s[8:11], s39 offen sc1
    v_mfma_f32_16x16x32_bf16 v[116:119], a[196:199], v[84:87], v[116:119]
    s_mul_i32 s27, s20, 12288
    v_mfma_f32_16x16x32_bf16 v[120:123], a[196:199], v[88:91], v[120:123]
    v_add_u32 v79, s27, v2
    v_mfma_f32_16x16x32_bf16 v[124:127], a[196:199], v[100:103], v[124:127]
    buffer_load_dwordx4 v[56:59], v248, s[8:11], s39 offen sc1
    v_mfma_f32_16x16x32_bf16 v[128:131], a[196:199], v[104:107], v[128:131]
    v_and_b32 v6, 15, v1
    v_mfma_f32_16x16x32_bf16 v[132:135], a[200:203], v[84:87], v[132:135]
    v_lshlrev_b32 v82, 10, v6
    v_mfma_f32_16x16x32_bf16 v[136:139], a[200:203], v[88:91], v[136:139]
    buffer_load_dwordx4 v[60:63], v249, s[8:11], s39 offen sc1
    v_mfma_f32_16x16x32_bf16 v[140:143], a[200:203], v[100:103], v[140:143]
    v_bfe_u32 v6, v1, 4, 1
    v_mfma_f32_16x16x32_bf16 v[144:147], a[200:203], v[104:107], v[144:147]
    s_waitcnt vmcnt(12)
    v_bitop3_b32 v78, v39, v67, s50 bitop3:0x7e
    v_mfma_f32_16x16x32_bf16 v[148:151], a[204:207], v[84:87], v[148:151]
    v_bitop3_b32 v81, v71, v75, s50 bitop3:0x7e
    v_mfma_f32_16x16x32_bf16 v[152:155], a[204:207], v[88:91], v[152:155]
    v_or_b32 v78, v78, v81
    v_mfma_f32_16x16x32_bf16 v[156:159], a[204:207], v[100:103], v[156:159]
    v_cmp_le_u32 vcc, 0x10000, v78
    v_mfma_f32_16x16x32_bf16 v[160:163], a[204:207], v[104:107], v[160:163]
    s_cbranch_vccnz sequential_preLN__ssm_conv_s4d__dense_activation_gelu__prompt_kernel_slow33
sequential_preLN__ssm_conv_s4d__dense_activation_gelu__prompt_kernel_back34:
    v_mfma_f32_16x16x32_bf16 v[92:95], a[16:19], v[36:39], v[92:95]
    s_add_u32 s39, s38, 8192
    buffer_load_dwordx4 v[84:87], v246, s[8:11], s39 offen sc1
    v_mfma_f32_16x16x32_bf16 v[96:99], a[16:19], v[64:67], v[96:99]
    v_lshl_add_u32 v82, v6, 5, v82
    v_mfma_f32_16x16x32_bf16 v[108:111], a[16:19], v[68:71], v[108:111]
    v_lshrrev_b32 v6, 5, v1
    v_mfma_f32_16x16x32_bf16 v[112:115], a[16:19], v[72:75], v[112:115]
    buffer_load_dwordx4 v[88:91], v247, s[8:11], s39 offen sc1
    v_mfma_f32_16x16x32_bf16 v[116:119], a[20:23], v[36:39], v[116:119]
    v_lshl_add_u32 v82, v6, 4, v82
    v_mfma_f32_16x16x32_bf16 v[120:123], a[20:23], v[64:67], v[120:123]
    s_lshl_b32 s4, s69, 16
    v_mfma_f32_16x16x32_bf16 v[124:127], a[20:23], v[68:71], v[124:127]
    buffer_load_dwordx4 v[100:103], v248, s[8:11], s39 offen sc1
    v_mfma_f32_16x16x32_bf16 v[128:131], a[20:23], v[72:75], v[128:131]
    s_lshl_b32 s28, s20, 14
    v_mfma_f32_16x16x32_bf16 v[132:135], a[24:27], v[36:39], v[132:135]
    s_add_u32 s4, s4, s28
    v_mfma_f32_16x16x32_bf16 v[136:139], a[24:27], v[64:67], v[136:139]
    buffer_load_dwordx4 v[104:107], v249, s[8:11], s39 offen sc1
    v_mfma_f32_16x16x32_bf16 v[140:143], a[24:27], v[68:71], v[140:143]
    s_add_u32 s4, s4, s47
    v_mfma_f32_16x16x32_bf16 v[144:147], a[24:27], v[72:75], v[144:147]
    s_waitcnt vmcnt(12)
    v_bitop3_b32 v78, v15, v19, s50 bitop3:0x7e
    v_mfma_f32_16x16x32_bf16 v[148:151], a[28:31], v[36:39], v[148:151]
    v_bitop3_b32 v81, v23, v27, s50 bitop3:0x7e
    v_mfma_f32_16x16x32_bf16 v[152:155], a[28:31], v[64:67], v[152:155]
    v_or_b32 v78, v78, v81
    v_mfma_f32_16x16x32_bf16 v[156:159], a[28:31], v[68:71], v[156:159]
    v_cmp_le_u32 vcc, 0x10000, v78
    v_mfma_f32_16x16x32_bf16 v[160:163], a[28:31], v[72:75], v[160:163]
    s_cbranch_vccnz sequential_preLN__ssm_conv_s4d__dense_activation_gelu__prompt_kernel_slow35
sequential_preLN__ssm_conv_s4d__dense_activation_gelu__prompt_kernel_back36:
    v_mfma_f32_16x16x32_bf16 v[92:95], a[80:83], v[12:15], v[92:95]
    s_add_u32 s39, s38, 24576
    buffer_load_dwordx4 v[36:39], v246, s[8:11], s39 offen sc1
    v_mfma_f32_16x16x32_bf16 v[96:99], a[80:83], v[16:19], v[96:99]
    s_mov_b32 s12, s60
    v_mfma_f32_16x16x32_bf16 v[108:111], a[80:83], v[20:23], v[108:111]
    s_mov_b32 s13, s61
    v_mfma_f32_16x16x32_bf16 v[112:115], a[80:83], v[24:27], v[112:115]
    buffer_load_dwordx4 v[64:67], v247, s[8:11], s39 offen sc1
    v_mfma_f32_16x16x32_bf16 v[116:119], a[84:87], v[12:15], v[116:119]
    s_mov_b32 s14, 0x200000
    v_mfma_f32_16x16x32_bf16 v[120:123], a[84:87], v[16:19], v[120:123]
    s_mov_b32 s15, 0x00020000
    v_mfma_f32_16x16x32_bf16 v[124:127], a[84:87], v[20:23], v[124:127]
    buffer_load_dwordx4 v[68:71], v248, s[8:11], s39 offen sc1
    v_mfma_f32_16x16x32_bf16 v[128:131], a[84:87], v[24:27], v[128:131]
    s_waitcnt lgkmcnt(0)
    v_mfma_f32_16x16x32_bf16 v[132:135], a[88:91], v[12:15], v[132:135]
    v_lshlrev_b32 v172, 16, v164
    v_mfma_f32_16x16x32_bf16 v[136:139], a[88:91], v[16:19], v[136:139]
    buffer_load_dwordx4 v[72:75], v249, s[8:11], s39 offen sc1
    v_mfma_f32_16x16x32_bf16 v[140:143], a[88:91], v[20:23], v[140:143]
    v_and_b32 v173, 0xffff0000, v164
    v_mfma_f32_16x16x32_bf16 v[144:147], a[88:91], v[24:27], v[144:147]
    s_waitcnt vmcnt(12)
    v_bitop3_b32 v78, v31, v35, s50 bitop3:0x7e
    v_mfma_f32_16x16x32_bf16 v[148:151], a[92:95], v[12:15], v[148:151]
    v_bitop3_b32 v81, v43, v47, s50 bitop3:0x7e
    v_mfma_f32_16x16x32_bf16 v[152:155], a[92:95], v[16:19], v[152:155]
    v_or_b32 v78, v78, v81
    v_mfma_f32_16x16x32_bf16 v[156:159], a[92:95], v[20:23], v[156:159]
    v_cmp_le_u32 vcc, 0x10000, v78
    v_mfma_f32_16x16x32_bf16 v[160:163], a[92:95], v[24:27], v[160:163]
    s_cbranch_vccnz sequential_preLN__ssm_conv_s4d__dense_activation_gelu__prompt_kernel_slow37
sequential_preLN__ssm_conv_s4d__dense_activation_gelu__prompt_kernel_back38:
    v_mfma_f32_16x16x32_bf16 v[92:95], a[144:147], v[28:31], v[92:95]
    s_add_u32 s39, s38, 40960
    buffer_load_dwordx4 v[12:15], v246, s[8:11], s39 offen sc1
    v_mfma_f32_16x16x32_bf16 v[96:99], a[144:147], v[32:35], v[96:99]
    v_lshlrev_b32 v174, 16, v165
    v_mfma_f32_16x16x32_bf16 v[108:111], a[144:147], v[40:43], v[108:111]
    v_and_b32 v175, 0xffff0000, v165
    v_mfma_f32_16x16x32_bf16 v[112:115], a[144:147], v[44:47], v[112:115]
    buffer_load_dwordx4 v[16:19], v247, s[8:11], s39 offen sc1
    v_mfma_f32_16x16x32_bf16 v[116:119], a[148:151], v[28:31], v[116:119]
    v_lshlrev_b32 v83, 16, v236
    v_mfma_f32_16x16x32_bf16 v[120:123], a[148:151], v[32:35], v[120:123]
    v_and_b32 v188, 0xffff0000, v236
    v_mfma_f32_16x16x32_bf16 v[124:127], a[148:151], v[40:43], v[124:127]
    buffer_load_dwordx4 v[20:23], v248, s[8:11], s39 offen sc1
    v_mfma_f32_16x16x32_bf16 v[128:131], a[148:151], v[44:47], v[128:131]
    v_add_f32 v172, v172, v83
    v_mfma_f32_16x16x32_bf16 v[132:135], a[152:155], v[28:31], v[132:135]
    v_add_f32 v173, v173, v188
    v_mfma_f32_16x16x32_bf16 v[136:139], a[152:155], v[32:35], v[136:139]
    buffer_load_dwordx4 v[24:27], v249, s[8:11], s39 offen sc1
    v_mfma_f32_16x16x32_bf16 v[140:143], a[152:155], v[40:43], v[140:143]
    v_lshlrev_b32 v83, 16, v237
    v_mfma_f32_16x16x32_bf16 v[144:147], a[152:155], v[44:47], v[144:147]
    s_waitcnt vmcnt(12)
    v_bitop3_b32 v78, v51, v55, s50 bitop3:0x7e
    v_mfma_f32_16x16x32_bf16 v[148:151], a[156:159], v[28:31], v[148:151]
    v_bitop3_b32 v81, v59, v63, s50 bitop3:0x7e
    v_mfma_f32_16x16x32_bf16 v[152:155], a[156:159], v[32:35], v[152:155]
    v_or_b32 v78, v78, v81
    v_mfma_f32_16x16x32_bf16 v[156:159], a[156:159], v[40:43], v[156:159]
    v_cmp_le_u32 vcc, 0x10000, v78
    v_mfma_f32_16x16x32_bf16 v[160:163], a[156:159], v[44:47], v[160:163]
    s_cbranch_vccnz sequential_preLN__ssm_conv_s4d__dense_activation_gelu__prompt_kernel_slow39
sequential_preLN__ssm_conv_s4d__dense_activation_gelu__prompt_kernel_back40:
    v_mfma_f32_16x16x32_bf16 v[92:95], a[208:211], v[48:51], v[92:95]
    s_add_u32 s39, s38, 57344
    buffer_load_dwordx4 v[28:31], v246, s[8:11], s39 offen sc1
    v_mfma_f32_16x16x32_bf16 v[96:99], a[208:211], v[52:55], v[96:99]
    v_and_b32 v188, 0xffff0000, v237
    v_mfma_f32_16x16x32_bf16 v[108:111], a[208:211], v[56:59], v[108:111]
    v_add_f32 v174, v174, v83
    v_mfma_f32_16x16x32_bf16 v[112:115], a[208:211], v[60:63], v[112:115]
    buffer_load_dwordx4 v[32:35], v247, s[8:11], s39 offen sc1
    v_mfma_f32_16x16x32_bf16 v[116:119], a[212:215], v[48:51], v[116:119]
    v_add_f32 v175, v175, v188
    v_mfma_f32_16x16x32_bf16 v[120:123], a[212:215], v[52:55], v[120:123]
    v_lshlrev_b32 v176, 16, v166
    v_mfma_f32_16x16x32_bf16 v[124:127], a[212:215], v[56:59], v[124:127]
    buffer_load_dwordx4 v[40:43], v248, s[8:11], s39 offen sc1
    v_mfma_f32_16x16x32_bf16 v[128:131], a[212:215], v[60:63], v[128:131]
    v_and_b32 v177, 0xffff0000, v166
    v_mfma_f32_16x16x32_bf16 v[132:135], a[216:219], v[48:51], v[132:135]
    v_lshlrev_b32 v178, 16, v167
    v_mfma_f32_16x16x32_bf16 v[136:139], a[216:219], v[52:55], v[136:139]
    buffer_load_dwordx4 v[44:47], v249, s[8:11], s39 offen sc1
    v_mfma_f32_16x16x32_bf16 v[140:143], a[216:219], v[56:59], v[140:143]
    v_and_b32 v179, 0xffff0000, v167
    v_mfma_f32_16x16x32_bf16 v[144:147], a[216:219], v[60:63], v[144:147]
    s_waitcnt vmcnt(12)
    v_bitop3_b32 v78, v87, v91, s50 bitop3:0x7e
    v_mfma_f32_16x16x32_bf16 v[148:151], a[220:223], v[48:51], v[148:151]
    v_bitop3_b32 v81, v103, v107, s50 bitop3:0x7e
    v_mfma_f32_16x16x32_bf16 v[152:155], a[220:223], v[52:55], v[152:155]
    v_or_b32 v78, v78, v81
    v_mfma_f32_16x16x32_bf16 v[156:159], a[220:223], v[56:59], v[156:159]
    v_cmp_le_u32 vcc, 0x10000, v78
    v_mfma_f32_16x16x32_bf16 v[160:163], a[220:223], v[60:63], v[160:163]
    s_cbranch_vccnz sequential_preLN__ssm_conv_s4d__dense_activation_gelu__prompt_kernel_slow41
sequential_preLN__ssm_conv_s4d__dense_activation_gelu__prompt_kernel_back42:
    v_mfma_f32_16x16x32_bf16 v[92:95], a[32:35], v[84:87], v[92:95]
    s_add_u32 s39, s38, 12288
    buffer_load_dwordx4 v[48:51], v246, s[8:11], s39 offen sc1
    v_mfma_f32_16x16x32_bf16 v[96:99], a[32:35], v[88:91], v[96:99]
    v_lshlrev_b32 v83, 16, v238
    v_mfma_f32_16x16x32_bf16 v[108:111], a[32:35], v[100:103], v[108:111]
    v_and_b32 v188, 0xffff0000, v238
    v_mfma_f32_16x16x32_bf16 v[112:115], a[32:35], v[104:107], v[112:115]
    buffer_load_dwordx4 v[52:55], v247, s[8:11], s39 offen sc1
    v_mfma_f32_16x16x32_bf16 v[116:119], a[36:39], v[84:87], v[116:119]
    v_add_f32 v176, v176, v83
    v_mfma_f32_16x16x32_bf16 v[120:123], a[36:39], v[88:91], v[120:123]
    v_add_f32 v177, v177, v188
    v_mfma_f32_16x16x32_bf16 v[124:127], a[36:39], v[100:103], v[124:127]
    buffer_load_dwordx4 v[56:59], v248, s[8:11], s39 offen sc1
    v_mfma_f32_16x16x32_bf16 v[128:131], a[36:39], v[104:107], v[128:131]
    v_lshlrev_b32 v83, 16, v239
    v_mfma_f32_16x16x32_bf16 v[132:135], a[40:43], v[84:87], v[132:135]
    v_and_b32 v188, 0xffff0000, v239
    v_mfma_f32_16x16x32_bf16 v[136:139], a[40:43], v[88:91], v[136:139]
    buffer_load_dwordx4 v[60:63], v249, s[8:11], s39 offen sc1
    v_mfma_f32_16x16x32_bf16 v[140:143], a[40:43], v[100:103], v[140:143]
    v_add_f32 v178, v178, v83
    v_mfma_f32_16x16x32_bf16 v[144:147], a[40:43], v[104:107], v[144:147]
    s_waitcnt vmcnt(12)
    v_bitop3_b32 v78, v39, v67, s50 bitop3:0x7e
    v_mfma_f32_16x16x32_bf16 v[148:151], a[44:47], v[84:87], v[148:151]
    v_bitop3_b32 v81, v71, v75, s50 bitop3:0x7e
    v_mfma_f32_16x16x32_bf16 v[152:155], a[44:47], v[88:91], v[152:155]
    v_or_b32 v78, v78, v81
    v_mfma_f32_16x16x32_bf16 v[156:159], a[44:47], v[100:103], v[156:159]
    v_cmp_le_u32 vcc, 0x10000, v78
    v_mfma_f32_16x16x32_bf16 v[160:163], a[44:47], v[104:107], v[160:163]
    s_cbranch_vccnz sequential_preLN__ssm_conv_s4d__dense_activation_gelu__prompt_kernel_slow43
sequential_preLN__ssm_conv_s4d__dense_activation_gelu__prompt_kernel_back44:
    v_mfma_f32_16x16x32_bf16 v[92:95], a[96:99], v[36:39], v[92:95]
    s_add_u32 s39, s38, 28672
    buffer_load_dwordx4 v[84:87], v246, s[8:11], s39 offen sc1
    v_mfma_f32_16x16x32_bf16 v[96:99], a[96:99], v[64:67], v[96:99]
    v_add_f32 v179, v179, v188
    v_mfma_f32_16x16x32_bf16 v[108:111], a[96:99], v[68:71], v[108:111]
    v_lshlrev_b32 v180, 16, v168
    v_mfma_f32_16x16x32_bf16 v[112:115], a[96:99], v[72:75], v[112:115]
    buffer_load_dwordx4 v[88:91], v247, s[8:11], s39 offen sc1
    v_mfma_f32_16x16x32_bf16 v[116:119], a[100:103], v[36:39], v[116:119]
    v_and_b32 v181, 0xffff0000, v168
    v_mfma_f32_16x16x32_bf16 v[120:123], a[100:103], v[64:67], v[120:123]
    v_lshlrev_b32 v182, 16, v169
    v_mfma_f32_16x16x32_bf16 v[124:127], a[100:103], v[68:71], v[124:127]
    buffer_load_dwordx4 v[100:103], v248, s[8:11], s39 offen sc1
    v_mfma_f32_16x16x32_bf16 v[128:131], a[100:103], v[72:75], v[128:131]
    v_and_b32 v183, 0xffff0000, v169
    v_mfma_f32_16x16x32_bf16 v[132:135], a[104:107], v[36:39], v[132:135]
    v_lshlrev_b32 v83, 16, v240
    v_mfma_f32_16x16x32_bf16 v[136:139], a[104:107], v[64:67], v[136:139]
    buffer_load_dwordx4 v[104:107], v249, s[8:11], s39 offen sc1
    v_mfma_f32_16x16x32_bf16 v[140:143], a[104:107], v[68:71], v[140:143]
    v_and_b32 v188, 0xffff0000, v240
    v_mfma_f32_16x16x32_bf16 v[144:147], a[104:107], v[72:75], v[144:147]
    s_waitcnt vmcnt(12)
    v_bitop3_b32 v78, v15, v19, s50 bitop3:0x7e
    v_mfma_f32_16x16x32_bf16 v[148:151], a[108:111], v[36:39], v[148:151]
    v_bitop3_b32 v81, v23, v27, s50 bitop3:0x7e
    v_mfma_f32_16x16x32_bf16 v[152:155], a[108:111], v[64:67], v[152:155]
    v_or_b32 v78, v78, v81
    v_mfma_f32_16x16x32_bf16 v[156:159], a[108:111], v[68:71], v[156:159]
    v_cmp_le_u32 vcc, 0x10000, v78
    v_mfma_f32_16x16x32_bf16 v[160:163], a[108:111], v[72:75], v[160:163]
    s_cbranch_vccnz sequential_preLN__ssm_conv_s4d__dense_activation_gelu__prompt_kernel_slow45
sequential_preLN__ssm_conv_s4d__dense_activation_gelu__prompt_kernel_back46:
    v_mfma_f32_16x16x32_bf16 v[92:95], a[160:163], v[12:15], v[92:95]
    s_add_u32 s39, s38, 45056
    buffer_load_dwordx4 v[36:39], v246, s[8:11], s39 offen sc1
    v_mfma_f32_16x16x32_bf16 v[96:99], a[160:163], v[16:19], v[96:99]
    v_add_f32 v180, v180, v83
    v_mfma_f32_16x16x32_bf16 v[108:111], a[160:163], v[20:23], v[108:111]
    v_add_f32 v181, v181, v188
    v_mfma_f32_16x16x32_bf16 v[112:115], a[160:163], v[24:27], v[112:115]
    buffer_load_dwordx4 v[64:67], v247, s[8:11], s39 offen sc1
    v_mfma_f32_16x16x32_bf16 v[116:119], a[164:167], v[12:15], v[116:119]
    v_lshlrev_b32 v83, 16, v241
    v_mfma_f32_16x16x32_bf16 v[120:123], a[164:167], v[16:19], v[120:123]
    v_and_b32 v188, 0xffff0000, v241
    v_mfma_f32_16x16x32_bf16 v[124:127], a[164:167], v[20:23], v[124:127]
    buffer_load_dwordx4 v[68:71], v248, s[8:11], s39 offen sc1
    v_mfma_f32_16x16x32_bf16 v[128:131], a[164:167], v[24:27], v[128:131]
    v_add_f32 v182, v182, v83
    v_mfma_f32_16x16x32_bf16 v[132:135], a[168:171], v[12:15], v[132:135]
    v_add_f32 v183, v183, v188
    v_mfma_f32_16x16x32_bf16 v[136:139], a[168:171], v[16:19], v[136:139]
    buffer_load_dwordx4 v[72:75], v249, s[8:11], s39 offen sc1
    v_mfma_f32_16x16x32_bf16 v[140:143], a[168:171], v[20:23], v[140:143]
    v_lshlrev_b32 v184, 16, v170
    v_mfma_f32_16x16x32_bf16 v[144:147], a[168:171], v[24:27], v[144:147]
    s_waitcnt vmcnt(12)
    v_bitop3_b32 v78, v31, v35, s50 bitop3:0x7e
    v_mfma_f32_16x16x32_bf16 v[148:151], a[172:175], v[12:15], v[148:151]
    v_bitop3_b32 v81, v43, v47, s50 bitop3:0x7e
    v_mfma_f32_16x16x32_bf16 v[152:155], a[172:175], v[16:19], v[152:155]
    v_or_b32 v78, v78, v81
    v_mfma_f32_16x16x32_bf16 v[156:159], a[172:175], v[20:23], v[156:159]
    v_cmp_le_u32 vcc, 0x10000, v78
    v_mfma_f32_16x16x32_bf16 v[160:163], a[172:175], v[24:27], v[160:163]
    s_cbranch_vccnz sequential_preLN__ssm_conv_s4d__dense_activation_gelu__prompt_kernel_slow47
sequential_preLN__ssm_conv_s4d__dense_activation_gelu__prompt_kernel_back48:
    v_mfma_f32_16x16x32_bf16 v[92:95], a[224:227], v[28:31], v[92:95]
    s_add_u32 s39, s38, 61440
    buffer_load_dwordx4 v[12:15], v246, s[8:11], s39 offen sc1
    v_mfma_f32_16x16x32_bf16 v[96:99], a[224:227], v[32:35], v[96:99]
    v_and_b32 v185, 0xffff0000, v170
    v_mfma_f32_16x16x32_bf16 v[108:111], a[224:227], v[40:43], v[108:111]
    v_lshlrev_b32 v186, 16, v171
    v_mfma_f32_16x16x32_bf16 v[112:115], a[224:227], v[44:47], v[112:115]
    buffer_load_dwordx4 v[16:19], v247, s[8:11], s39 offen sc1
    v_mfma_f32_16x16x32_bf16 v[116:119], a[228:231], v[28:31], v[116:119]
    v_and_b32 v187, 0xffff0000, v171
    v_mfma_f32_16x16x32_bf16 v[120:123], a[228:231], v[32:35], v[120:123]
    v_lshlrev_b32 v83, 16, v242
    v_mfma_f32_16x16x32_bf16 v[124:127], a[228:231], v[40:43], v[124:127]
    buffer_load_dwordx4 v[20:23], v248, s[8:11], s39 offen sc1
    v_mfma_f32_16x16x32_bf16 v[128:131], a[228:231], v[44:47], v[128:131]
    v_and_b32 v188, 0xffff0000, v242
    v_mfma_f32_16x16x32_bf16 v[132:135], a[232:235], v[28:31], v[132:135]
    v_add_f32 v184, v184, v83
    v_mfma_f32_16x16x32_bf16 v[136:139], a[232:235], v[32:35], v[136:139]
    buffer_load_dwordx4 v[24:27], v249, s[8:11], s39 offen sc1
    v_mfma_f32_16x16x32_bf16 v[140:143], a[232:235], v[40:43], v[140:143]
    v_add_f32 v185, v185, v188
    v_mfma_f32_16x16x32_bf16 v[144:147], a[232:235], v[44:47], v[144:147]
    s_waitcnt vmcnt(12)
    v_bitop3_b32 v78, v51, v55, s50 bitop3:0x7e
    v_mfma_f32_16x16x32_bf16 v[148:151], a[236:239], v[28:31], v[148:151]
    v_bitop3_b32 v81, v59, v63, s50 bitop3:0x7e
    v_mfma_f32_16x16x32_bf16 v[152:155], a[236:239], v[32:35], v[152:155]
    v_or_b32 v78, v78, v81
    v_mfma_f32_16x16x32_bf16 v[156:159], a[236:239], v[40:43], v[156:159]
    v_cmp_le_u32 vcc, 0x10000, v78
    v_mfma_f32_16x16x32_bf16 v[160:163], a[236:239], v[44:47], v[160:163]
    s_cbranch_vccnz sequential_preLN__ssm_conv_s4d__dense_activation_gelu__prompt_kernel_slow49
sequential_preLN__ssm_conv_s4d__dense_activation_gelu__prompt_kernel_back50:
    v_mfma_f32_16x16x32_bf16 v[92:95], a[48:51], v[48:51], v[92:95]
    v_lshlrev_b32 v83, 16, v243
    v_mfma_f32_16x16x32_bf16 v[96:99], a[48:51], v[52:55], v[96:99]
    v_and_b32 v188, 0xffff0000, v243
    v_mfma_f32_16x16x32_bf16 v[108:111], a[48:51], v[56:59], v[108:111]
    v_add_f32 v186, v186, v83
    v_mfma_f32_16x16x32_bf16 v[112:115], a[48:51], v[60:63], v[112:115]
    v_add_f32 v187, v187, v188
    v_mfma_f32_16x16x32_bf16 v[116:119], a[52:55], v[48:51], v[116:119]
    v_mfma_f32_16x16x32_bf16 v[120:123], a[52:55], v[52:55], v[120:123]
    v_mfma_f32_16x16x32_bf16 v[124:127], a[52:55], v[56:59], v[124:127]
    v_mfma_f32_16x16x32_bf16 v[128:131], a[52:55], v[60:63], v[128:131]
    v_mfma_f32_16x16x32_bf16 v[132:135], a[56:59], v[48:51], v[132:135]
    v_mfma_f32_16x16x32_bf16 v[136:139], a[56:59], v[52:55], v[136:139]
    v_mfma_f32_16x16x32_bf16 v[140:143], a[56:59], v[56:59], v[140:143]
    v_mfma_f32_16x16x32_bf16 v[144:147], a[56:59], v[60:63], v[144:147]
    s_waitcnt vmcnt(8)
    v_bitop3_b32 v78, v87, v91, s50 bitop3:0x7e
    v_mfma_f32_16x16x32_bf16 v[148:151], a[60:63], v[48:51], v[148:151]
    v_bitop3_b32 v81, v103, v107, s50 bitop3:0x7e
    v_mfma_f32_16x16x32_bf16 v[152:155], a[60:63], v[52:55], v[152:155]
    v_or_b32 v78, v78, v81
    v_mfma_f32_16x16x32_bf16 v[156:159], a[60:63], v[56:59], v[156:159]
    v_cmp_le_u32 vcc, 0x10000, v78
    v_mfma_f32_16x16x32_bf16 v[160:163], a[60:63], v[60:63], v[160:163]
    s_cbranch_vccnz sequential_preLN__ssm_conv_s4d__dense_activation_gelu__prompt_kernel_slow51
sequential_preLN__ssm_conv_s4d__dense_activation_gelu__prompt_kernel_back52:
    v_mfma_f32_16x16x32_bf16 v[92:95], a[112:115], v[84:87], v[92:95]
    v_mfma_f32_16x16x32_bf16 v[96:99], a[112:115], v[88:91], v[96:99]
    v_mfma_f32_16x16x32_bf16 v[108:111], a[112:115], v[100:103], v[108:111]
    v_mfma_f32_16x16x32_bf16 v[112:115], a[112:115], v[104:107], v[112:115]
    v_mfma_f32_16x16x32_bf16 v[116:119], a[116:119], v[84:87], v[116:119]
    v_mfma_f32_16x16x32_bf16 v[120:123], a[116:119], v[88:91], v[120:123]
    v_mfma_f32_16x16x32_bf16 v[124:127], a[116:119], v[100:103], v[124:127]
    v_mfma_f32_16x16x32_bf16 v[128:131], a[116:119], v[104:107], v[128:131]
    v_mfma_f32_16x16x32_bf16 v[132:135], a[120:123], v[84:87], v[132:135]
    v_mfma_f32_16x16x32_bf16 v[136:139], a[120:123], v[88:91], v[136:139]
    v_mfma_f32_16x16x32_bf16 v[140:143], a[120:123], v[100:103], v[140:143]
    v_mfma_f32_16x16x32_bf16 v[144:147], a[120:123], v[104:107], v[144:147]
    s_waitcnt vmcnt(4)
    v_bitop3_b32 v78, v39, v67, s50 bitop3:0x7e
    v_mfma_f32_16x16x32_bf16 v[148:151], a[124:127], v[84:87], v[148:151]
    v_bitop3_b32 v81, v71, v75, s50 bitop3:0x7e
    v_mfma_f32_16x16x32_bf16 v[152:155], a[124:127], v[88:91], v[152:155]
    v_or_b32 v78, v78, v81
    v_mfma_f32_16x16x32_bf16 v[156:159], a[124:127], v[100:103], v[156:159]
    v_cmp_le_u32 vcc, 0x10000, v78
    v_mfma_f32_16x16x32_bf16 v[160:163], a[124:127], v[104:107], v[160:163]
    s_cbranch_vccnz sequential_preLN__ssm_conv_s4d__dense_activation_gelu__prompt_kernel_slow53
sequential_preLN__ssm_conv_s4d__dense_activation_gelu__prompt_kernel_back54:
    v_mfma_f32_16x16x32_bf16 v[92:95], a[176:179], v[36:39], v[92:95]
    v_mfma_f32_16x16x32_bf16 v[96:99], a[176:179], v[64:67], v[96:99]
    v_mfma_f32_16x16x32_bf16 v[108:111], a[176:179], v[68:71], v[108:111]
    v_mfma_f32_16x16x32_bf16 v[112:115], a[176:179], v[72:75], v[112:115]
    v_mfma_f32_16x16x32_bf16 v[116:119], a[180:183], v[36:39], v[116:119]
    v_mfma_f32_16x16x32_bf16 v[120:123], a[180:183], v[64:67], v[120:123]
    v_mfma_f32_16x16x32_bf16 v[124:127], a[180:183], v[68:71], v[124:127]
    v_mfma_f32_16x16x32_bf16 v[128:131], a[180:183], v[72:75], v[128:131]
    v_mfma_f32_16x16x32_bf16 v[132:135], a[184:187], v[36:39], v[132:135]
    v_mfma_f32_16x16x32_bf16 v[136:139], a[184:187], v[64:67], v[136:139]
    v_mfma_f32_16x16x32_bf16 v[140:143], a[184:187], v[68:71], v[140:143]
    v_mfma_f32_16x16x32_bf16 v[144:147], a[184:187], v[72:75], v[144:147]
    s_waitcnt vmcnt(0)
    v_bitop3_b32 v78, v15, v19, s50 bitop3:0x7e
    v_mfma_f32_16x16x32_bf16 v[148:151], a[188:191], v[36:39], v[148:151]
    v_bitop3_b32 v81, v23, v27, s50 bitop3:0x7e
    v_mfma_f32_16x16x32_bf16 v[152:155], a[188:191], v[64:67], v[152:155]
    v_or_b32 v78, v78, v81
    v_mfma_f32_16x16x32_bf16 v[156:159], a[188:191], v[68:71], v[156:159]
    v_cmp_le_u32 vcc, 0x10000, v78
    v_mfma_f32_16x16x32_bf16 v[160:163], a[188:191], v[72:75], v[160:163]
    s_cbranch_vccnz sequential_preLN__ssm_conv_s4d__dense_activation_gelu__prompt_kernel_slow55
sequential_preLN__ssm_conv_s4d__dense_activation_gelu__prompt_kernel_back56:
    v_mfma_f32_16x16x32_bf16 v[96:99], a[240:243], v[16:19], v[96:99]
    v_mfma_f32_16x16x32_bf16 v[120:123], a[244:247], v[16:19], v[120:123]
    v_mfma_f32_16x16x32_bf16 v[136:139], a[248:251], v[16:19], v[136:139]
    v_mfma_f32_16x16x32_bf16 v[152:155], a[252:255], v[16:19], v[152:155]
    v_mfma_f32_16x16x32_bf16 v[108:111], a[240:243], v[20:23], v[108:111]
    s_nop 3
    ds_write_b128 v11, v[96:99] offset:0
    v_mfma_f32_16x16x32_bf16 v[124:127], a[244:247], v[20:23], v[124:127]
    ds_write_b128 v11, v[120:123] offset:1024
    v_mfma_f32_16x16x32_bf16 v[140:143], a[248:251], v[20:23], v[140:143]
    ds_write_b128 v11, v[136:139] offset:2048
    v_mfma_f32_16x16x32_bf16 v[156:159], a[252:255], v[20:23], v[156:159]
    ds_write_b128 v11, v[152:155] offset:3072
    v_mfma_f32_16x16x32_bf16 v[112:115], a[240:243], v[24:27], v[112:115]
    ds_write_b128 v76, v[108:111] offset:0
    v_mfma_f32_16x16x32_bf16 v[128:131], a[244:247], v[24:27], v[128:131]
    ds_write_b128 v76, v[124:127] offset:1024
    v_mfma_f32_16x16x32_bf16 v[144:147], a[248:251], v[24:27], v[144:147]
    ds_write_b128 v76, v[140:143] offset:2048
    v_mfma_f32_16x16x32_bf16 v[160:163], a[252:255], v[24:27], v[160:163]
    ds_write_b128 v76, v[156:159] offset:3072
    v_mfma_f32_16x16x32_bf16 v[92:95], a[240:243], v[12:15], v[92:95]
    ds_write_b128 v77, v[112:115] offset:0
    v_mfma_f32_16x16x32_bf16 v[116:119], a[244:247], v[12:15], v[116:119]
    ds_write_b128 v77, v[128:131] offset:1024
    v_mfma_f32_16x16x32_bf16 v[132:135], a[248:251], v[12:15], v[132:135]
    ds_write_b128 v77, v[144:147] offset:2048
    v_mfma_f32_16x16x32_bf16 v[148:151], a[252:255], v[12:15], v[148:151]
    ds_write_b128 v77, v[160:163] offset:3072
    s_lshl_b32 s27, s2, 2
    s_add_u32 s27, s27, s20
    s_cmp_eq_u32 s27, 0
    s_cbranch_scc0 sequential_preLN__ssm_conv_s4d__dense_activation_gelu__prompt_kernel_ep57
    v_mov_b32 v6, s51
    v_mov_b32 v7, 4263936
    v_cmp_eq_u32 vcc, 0, v1
    s_nop 2
    s_and_saveexec_b64 s[6:7], vcc
    buffer_store_dword v6, v7, s[8:11], 0 offen
    s_mov_b64 exec, s[6:7]
sequential_preLN__ssm_conv_s4d__dense_activation_gelu__prompt_kernel_ep57:
    s_waitcnt lgkmcnt(0)
    s_barrier
    ds_read_b128 v[12:15], v79 offset:0
    ds_read_b128 v[28:31], v79 offset:4096
    ds_read_b128 v[48:51], v79 offset:8192
    ds_read_b128 v[16:19], v79 offset:1024
    ds_read_b128 v[32:35], v79 offset:5120
    ds_read_b128 v[52:55], v79 offset:9216
    ds_read_b128 v[20:23], v79 offset:2048
    ds_read_b128 v[40:43], v79 offset:6144
    ds_read_b128 v[56:59], v79 offset:10240
    ds_read_b128 v[24:27], v79 offset:3072
    ds_read_b128 v[44:47], v79 offset:7168
    ds_read_b128 v[60:63], v79 offset:11264
    s_waitcnt lgkmcnt(9)
    v_pk_add_f32 v[92:93], v[92:93], v[12:13]
    v_pk_add_f32 v[94:95], v[94:95], v[14:15]
    v_pk_add_f32 v[92:93], v[92:93], v[28:29]
    v_pk_add_f32 v[94:95], v[94:95], v[30:31]
    v_pk_add_f32 v[92:93], v[92:93], v[48:49]
    v_pk_add_f32 v[94:95], v[94:95], v[50:51]
    v_pk_add_f32 v[92:93], v[92:93], v[172:173]
    v_pk_add_f32 v[94:95], v[94:95], v[174:175]
    v_cvt_pk_bf16_f32 v36, v92, v93
    v_cvt_pk_bf16_f32 v37, v94, v95
    s_waitcnt lgkmcnt(6)
    v_pk_add_f32 v[116:117], v[116:117], v[16:17]
    v_pk_add_f32 v[118:119], v[118:119], v[18:19]
    v_pk_add_f32 v[116:117], v[116:117], v[32:33]
    v_pk_add_f32 v[118:119], v[118:119], v[34:35]
    v_pk_add_f32 v[116:117], v[116:117], v[52:53]
    v_pk_add_f32 v[118:119], v[118:119], v[54:55]
    v_pk_add_f32 v[116:117], v[116:117], v[176:177]
    v_pk_add_f32 v[118:119], v[118:119], v[178:179]
    v_cvt_pk_bf16_f32 v38, v116, v117
    v_cvt_pk_bf16_f32 v39, v118, v119
    s_nop 0
    v_permlane16_swap_b32 v36, v38
    v_permlane16_swap_b32 v37, v39
    buffer_store_dwordx4 v[36:39], v82, s[12:15], s4 offen offset:0 sc1 nt
    s_waitcnt lgkmcnt(3)
    v_pk_add_f32 v[132:133], v[132:133], v[20:21]
    v_pk_add_f32 v[134:135], v[134:135], v[22:23]
    v_pk_add_f32 v[132:133], v[132:133], v[40:41]
    v_pk_add_f32 v[134:135], v[134:135], v[42:43]
    v_pk_add_f32 v[132:133], v[132:133], v[56:57]
    v_pk_add_f32 v[134:135], v[134:135], v[58:59]
    v_pk_add_f32 v[132:133], v[132:133], v[180:181]
    v_pk_add_f32 v[134:135], v[134:135], v[182:183]
    v_cvt_pk_bf16_f32 v64, v132, v133
    v_cvt_pk_bf16_f32 v65, v134, v135
    s_waitcnt lgkmcnt(0)
    v_pk_add_f32 v[148:149], v[148:149], v[24:25]
    v_pk_add_f32 v[150:151], v[150:151], v[26:27]
    v_pk_add_f32 v[148:149], v[148:149], v[44:45]
    v_pk_add_f32 v[150:151], v[150:151], v[46:47]
    v_pk_add_f32 v[148:149], v[148:149], v[60:61]
    v_pk_add_f32 v[150:151], v[150:151], v[62:63]
    v_pk_add_f32 v[148:149], v[148:149], v[184:185]
    v_pk_add_f32 v[150:151], v[150:151], v[186:187]
    v_cvt_pk_bf16_f32 v66, v148, v149
    v_cvt_pk_bf16_f32 v67, v150, v151
    s_nop 0
    v_permlane16_swap_b32 v64, v66
    v_permlane16_swap_b32 v65, v67
    buffer_store_dwordx4 v[64:67], v82, s[12:15], s4 offen offset:64 sc1 nt
    s_endpgm
sequential_preLN__ssm_conv_s4d__dense_activation_gelu__prompt_kernel_exit1:
    s_endpgm
sequential_preLN__ssm_conv_s4d__dense_activation_gelu__prompt_kernel_w2s23:
    s_add_u32 s35, s34, 0
    buffer_load_dwordx4 a[0:3], v2, s[8:11], s35 offen offset:0 sc1
    buffer_load_dwordx4 a[4:7], v2, s[8:11], s35 offen offset:1024 sc1
    buffer_load_dwordx4 a[8:11], v2, s[8:11], s35 offen offset:2048 sc1
    buffer_load_dwordx4 a[12:15], v2, s[8:11], s35 offen offset:3072 sc1
    s_add_u32 s35, s34, 4096
    buffer_load_dwordx4 a[16:19], v2, s[8:11], s35 offen offset:0 sc1
    buffer_load_dwordx4 a[20:23], v2, s[8:11], s35 offen offset:1024 sc1
    buffer_load_dwordx4 a[24:27], v2, s[8:11], s35 offen offset:2048 sc1
    buffer_load_dwordx4 a[28:31], v2, s[8:11], s35 offen offset:3072 sc1
    s_add_u32 s35, s34, 8192
    buffer_load_dwordx4 a[32:35], v2, s[8:11], s35 offen offset:0 sc1
    buffer_load_dwordx4 a[36:39], v2, s[8:11], s35 offen offset:1024 sc1
    buffer_load_dwordx4 a[40:43], v2, s[8:11], s35 offen offset:2048 sc1
    buffer_load_dwordx4 a[44:47], v2, s[8:11], s35 offen offset:3072 sc1
    s_add_u32 s35, s34, 12288
    buffer_load_dwordx4 a[48:51], v2, s[8:11], s35 offen offset:0 sc1
    buffer_load_dwordx4 a[52:55], v2, s[8:11], s35 offen offset:1024 sc1
    buffer_load_dwordx4 a[56:59], v2, s[8:11], s35 offen offset:2048 sc1
    buffer_load_dwordx4 a[60:63], v2, s[8:11], s35 offen offset:3072 sc1
    s_add_u32 s35, s34, 16384
    buffer_load_dwordx4 a[64:67], v2, s[8:11], s35 offen offset:0 sc1
    buffer_load_dwordx4 a[68:71], v2, s[8:11], s35 offen offset:1024 sc1
    buffer_load_dwordx4 a[72:75], v2, s[8:11], s35 offen offset:2048 sc1
    buffer_load_dwordx4 a[76:79], v2, s[8:11], s35 offen offset:3072 sc1
    s_add_u32 s35, s34, 20480
    buffer_load_dwordx4 a[80:83], v2, s[8:11], s35 offen offset:0 sc1
    buffer_load_dwordx4 a[84:87], v2, s[8:11], s35 offen offset:1024 sc1
    buffer_load_dwordx4 a[88:91], v2, s[8:11], s35 offen offset:2048 sc1
    buffer_load_dwordx4 a[92:95], v2, s[8:11], s35 offen offset:3072 sc1
    s_waitcnt vmcnt(0)
    s_branch sequential_preLN__ssm_conv_s4d__dense_activation_gelu__prompt_kernel_w2b24
sequential_preLN__ssm_conv_s4d__dense_activation_gelu__prompt_kernel_slow25:
    s_add_u32 s40, s40, 1
    s_cmp_gt_u32 s40, 20000
    s_cbranch_scc1 sequential_preLN__ssm_conv_s4d__dense_activation_gelu__prompt_kernel_back26
    s_add_u32 s39, s38, 0
    buffer_load_dwordx4 v[12:15], v246, s[8:11], s39 offen sc1
    buffer_load_dwordx4 v[16:19], v247, s[8:11], s39 offen sc1
    buffer_load_dwordx4 v[20:23], v248, s[8:11], s39 offen sc1
    buffer_load_dwordx4 v[24:27], v249, s[8:11], s39 offen sc1
    s_waitcnt vmcnt(0)
    v_bitop3_b32 v78, v15, v19, s50 bitop3:0x7e
    v_bitop3_b32 v81, v23, v27, s50 bitop3:0x7e
    v_or_b32 v78, v78, v81
    v_cmp_le_u32 vcc, 0x10000, v78
    s_cbranch_vccnz sequential_preLN__ssm_conv_s4d__dense_activation_gelu__prompt_kernel_slow25
    s_add_u32 s39, s38, 16384
    buffer_load_dwordx4 v[28:31], v246, s[8:11], s39 offen sc1
    buffer_load_dwordx4 v[32:35], v247, s[8:11], s39 offen sc1
    buffer_load_dwordx4 v[40:43], v248, s[8:11], s39 offen sc1
    buffer_load_dwordx4 v[44:47], v249, s[8:11], s39 offen sc1
    s_add_u32 s39, s38, 32768
    buffer_load_dwordx4 v[48:51], v246, s[8:11], s39 offen sc1
    buffer_load_dwordx4 v[52:55], v247, s[8:11], s39 offen sc1
    buffer_load_dwordx4 v[56:59], v248, s[8:11], s39 offen sc1
    buffer_load_dwordx4 v[60:63], v249, s[8:11], s39 offen sc1
    s_add_u32 s39, s38, 49152
    buffer_load_dwordx4 v[84:87], v246, s[8:11], s39 offen sc1
    buffer_load_dwordx4 v[88:91], v247, s[8:11], s39 offen sc1
    buffer_load_dwordx4 v[100:103], v248, s[8:11], s39 offen sc1
    buffer_load_dwordx4 v[104:107], v249, s[8:11], s39 offen sc1
    s_branch sequential_preLN__ssm_conv_s4d__dense_activation_gelu__prompt_kernel_back26
sequential_preLN__ssm_conv_s4d__dense_activation_gelu__prompt_kernel_slow27:
    s_add_u32 s40, s40, 1
    s_cmp_gt_u32 s40, 20000
    s_cbranch_scc1 sequential_preLN__ssm_conv_s4d__dense_activation_gelu__prompt_kernel_back28
    s_add_u32 s39, s38, 16384
    buffer_load_dwordx4 v[28:31], v246, s[8:11], s39 offen sc1
    buffer_load_dwordx4 v[32:35], v247, s[8:11], s39 offen sc1
    buffer_load_dwordx4 v[40:43], v248, s[8:11], s39 offen sc1
    buffer_load_dwordx4 v[44:47], v249, s[8:11], s39 offen sc1
    s_waitcnt vmcnt(0)
    v_bitop3_b32 v78, v31, v35, s50 bitop3:0x7e
    v_bitop3_b32 v81, v43, v47, s50 bitop3:0x7e
    v_or_b32 v78, v78, v81
    v_cmp_le_u32 vcc, 0x10000, v78
    s_cbranch_vccnz sequential_preLN__ssm_conv_s4d__dense_activation_gelu__prompt_kernel_slow27
    s_add_u32 s39, s38, 32768
    buffer_load_dwordx4 v[48:51], v246, s[8:11], s39 offen sc1
    buffer_load_dwordx4 v[52:55], v247, s[8:11], s39 offen sc1
    buffer_load_dwordx4 v[56:59], v248, s[8:11], s39 offen sc1
    buffer_load_dwordx4 v[60:63], v249, s[8:11], s39 offen sc1
    s_add_u32 s39, s38, 49152
    buffer_load_dwordx4 v[84:87], v246, s[8:11], s39 offen sc1
    buffer_load_dwordx4 v[88:91], v247, s[8:11], s39 offen sc1
    buffer_load_dwordx4 v[100:103], v248, s[8:11], s39 offen sc1
    buffer_load_dwordx4 v[104:107], v249, s[8:11], s39 offen sc1
    s_add_u32 s39, s38, 4096
    buffer_load_dwordx4 v[36:39], v246, s[8:11], s39 offen sc1
    buffer_load_dwordx4 v[64:67], v247, s[8:11], s39 offen sc1
    buffer_load_dwordx4 v[68:71], v248, s[8:11], s39 offen sc1
    buffer_load_dwordx4 v[72:75], v249, s[8:11], s39 offen sc1
    s_branch sequential_preLN__ssm_conv_s4d__dense_activation_gelu__prompt_kernel_back28
sequential_preLN__ssm_conv_s4d__dense_activation_gelu__prompt_kernel_slow29:
    s_add_u32 s40, s40, 1
    s_cmp_gt_u32 s40, 20000
    s_cbranch_scc1 sequential_preLN__ssm_conv_s4d__dense_activation_gelu__prompt_kernel_back30
    s_add_u32 s39, s38, 32768
    buffer_load_dwordx4 v[48:51], v246, s[8:11], s39 offen sc1
    buffer_load_dwordx4 v[52:55], v247, s[8:11], s39 offen sc1
    buffer_load_dwordx4 v[56:59], v248, s[8:11], s39 offen sc1
    buffer_load_dwordx4 v[60:63], v249, s[8:11], s39 offen sc1
    s_waitcnt vmcnt(0)
    v_bitop3_b32 v78, v51, v55, s50 bitop3:0x7e
    v_bitop3_b32 v81, v59, v63, s50 bitop3:0x7e
    v_or_b32 v78, v78, v81
    v_cmp_le_u32 vcc, 0x10000, v78
    s_cbranch_vccnz sequential_preLN__ssm_conv_s4d__dense_activation_gelu__prompt_kernel_slow29
    s_add_u32 s39, s38, 49152
    buffer_load_dwordx4 v[84:87], v246, s[8:11], s39 offen sc1
    buffer_load_dwordx4 v[88:91], v247, s[8:11], s39 offen sc1
    buffer_load_dwordx4 v[100:103], v248, s[8:11], s39 offen sc1
    buffer_load_dwordx4 v[104:107], v249, s[8:11], s39 offen sc1
    s_add_u32 s39, s38, 4096
    buffer_load_dwordx4 v[36:39], v246, s[8:11], s39 offen sc1
    buffer_load_dwordx4 v[64:67], v247, s[8:11], s39 offen sc1
    buffer_load_dwordx4 v[68:71], v248, s[8:11], s39 offen sc1
    buffer_load_dwordx4 v[72:75], v249, s[8:11], s39 offen sc1
    s_add_u32 s39, s38, 20480
    buffer_load_dwordx4 v[12:15], v246, s[8:11], s39 offen sc1
    buffer_load_dwordx4 v[16:19], v247, s[8:11], s39 offen sc1
    buffer_load_dwordx4 v[20:23], v248, s[8:11], s39 offen sc1
    buffer_load_dwordx4 v[24:27], v249, s[8:11], s39 offen sc1
    s_branch sequential_preLN__ssm_conv_s4d__dense_activation_gelu__prompt_kernel_back30
sequential_preLN__ssm_conv_s4d__dense_activation_gelu__prompt_kernel_slow31:
    s_add_u32 s40, s40, 1
    s_cmp_gt_u32 s40, 20000
    s_cbranch_scc1 sequential_preLN__ssm_conv_s4d__dense_activation_gelu__prompt_kernel_back32
    s_add_u32 s39, s38, 49152
    buffer_load_dwordx4 v[84:87], v246, s[8:11], s39 offen sc1
    buffer_load_dwordx4 v[88:91], v247, s[8:11], s39 offen sc1
    buffer_load_dwordx4 v[100:103], v248, s[8:11], s39 offen sc1
    buffer_load_dwordx4 v[104:107], v249, s[8:11], s39 offen sc1
    s_waitcnt vmcnt(0)
    v_bitop3_b32 v78, v87, v91, s50 bitop3:0x7e
    v_bitop3_b32 v81, v103, v107, s50 bitop3:0x7e
    v_or_b32 v78, v78, v81
    v_cmp_le_u32 vcc, 0x10000, v78
    s_cbranch_vccnz sequential_preLN__ssm_conv_s4d__dense_activation_gelu__prompt_kernel_slow31
    s_add_u32 s39, s38, 4096
    buffer_load_dwordx4 v[36:39], v246, s[8:11], s39 offen sc1
    buffer_load_dwordx4 v[64:67], v247, s[8:11], s39 offen sc1
    buffer_load_dwordx4 v[68:71], v248, s[8:11], s39 offen sc1
    buffer_load_dwordx4 v[72:75], v249, s[8:11], s39 offen sc1
    s_add_u32 s39, s38, 20480
    buffer_load_dwordx4 v[12:15], v246, s[8:11], s39 offen sc1
    buffer_load_dwordx4 v[16:19], v247, s[8:11], s39 offen sc1
    buffer_load_dwordx4 v[20:23], v248, s[8:11], s39 offen sc1
    buffer_load_dwordx4 v[24:27], v249, s[8:11], s39 offen sc1
    s_add_u32 s39, s38, 36864
    buffer_load_dwordx4 v[28:31], v246, s[8:11], s39 offen sc1
    buffer_load_dwordx4 v[32:35], v247, s[8:11], s39 offen sc1
    buffer_load_dwordx4 v[40:43], v248, s[8:11], s39 offen sc1
    buffer_load_dwordx4 v[44:47], v249, s[8:11], s39 offen sc1
    s_branch sequential_preLN__ssm_conv_s4d__dense_activation_gelu__prompt_kernel_back32
sequential_preLN__ssm_conv_s4d__dense_activation_gelu__prompt_kernel_slow33:
    s_add_u32 s40, s40, 1
    s_cmp_gt_u32 s40, 20000
    s_cbranch_scc1 sequential_preLN__ssm_conv_s4d__dense_activation_gelu__prompt_kernel_back34
    s_add_u32 s39, s38, 4096
    buffer_load_dwordx4 v[36:39], v246, s[8:11], s39 offen sc1
    buffer_load_dwordx4 v[64:67], v247, s[8:11], s39 offen sc1
    buffer_load_dwordx4 v[68:71], v248, s[8:11], s39 offen sc1
    buffer_load_dwordx4 v[72:75], v249, s[8:11], s39 offen sc1
    s_waitcnt vmcnt(0)
    v_bitop3_b32 v78, v39, v67, s50 bitop3:0x7e
    v_bitop3_b32 v81, v71, v75, s50 bitop3:0x7e
    v_or_b32 v78, v78, v81
    v_cmp_le_u32 vcc, 0x10000, v78
    s_cbranch_vccnz sequential_preLN__ssm_conv_s4d__dense_activation_gelu__prompt_kernel_slow33
    s_add_u32 s39, s38, 20480
    buffer_load_dwordx4 v[12:15], v246, s[8:11], s39 offen sc1
    buffer_load_dwordx4 v[16:19], v247, s[8:11], s39 offen sc1
    buffer_load_dwordx4 v[20:23], v248, s[8:11], s39 offen sc1
    buffer_load_dwordx4 v[24:27], v249, s[8:11], s39 offen sc1
    s_add_u32 s39, s38, 36864
    buffer_load_dwordx4 v[28:31], v246, s[8:11], s39 offen sc1
    buffer_load_dwordx4 v[32:35], v247, s[8:11], s39 offen sc1
    buffer_load_dwordx4 v[40:43], v248, s[8:11], s39 offen sc1
    buffer_load_dwordx4 v[44:47], v249, s[8:11], s39 offen sc1
    s_add_u32 s39, s38, 53248
    buffer_load_dwordx4 v[48:51], v246, s[8:11], s39 offen sc1
    buffer_load_dwordx4 v[52:55], v247, s[8:11], s39 offen sc1
    buffer_load_dwordx4 v[56:59], v248, s[8:11], s39 offen sc1
    buffer_load_dwordx4 v[60:63], v249, s[8:11], s39 offen sc1
    s_branch sequential_preLN__ssm_conv_s4d__dense_activation_gelu__prompt_kernel_back34
sequential_preLN__ssm_conv_s4d__dense_activation_gelu__prompt_kernel_slow35:
    s_add_u32 s40, s40, 1
    s_cmp_gt_u32 s40, 20000
    s_cbranch_scc1 sequential_preLN__ssm_conv_s4d__dense_activation_gelu__prompt_kernel_back36
    s_add_u32 s39, s38, 20480
    buffer_load_dwordx4 v[12:15], v246, s[8:11], s39 offen sc1
    buffer_load_dwordx4 v[16:19], v247, s[8:11], s39 offen sc1
    buffer_load_dwordx4 v[20:23], v248, s[8:11], s39 offen sc1
    buffer_load_dwordx4 v[24:27], v249, s[8:11], s39 offen sc1
    s_waitcnt vmcnt(0)
    v_bitop3_b32 v78, v15, v19, s50 bitop3:0x7e
    v_bitop3_b32 v81, v23, v27, s50 bitop3:0x7e
    v_or_b32 v78, v78, v81
    v_cmp_le_u32 vcc, 0x10000, v78
    s_cbranch_vccnz sequential_preLN__ssm_conv_s4d__dense_activation_gelu__prompt_kernel_slow35
    s_add_u32 s39, s38, 36864
    buffer_load_dwordx4 v[28:31], v246, s[8:11], s39 offen sc1
    buffer_load_dwordx4 v[32:35], v247, s[8:11], s39 offen sc1
    buffer_load_dwordx4 v[40:43], v248, s[8:11], s39 offen sc1
    buffer_load_dwordx4 v[44:47], v249, s[8:11], s39 offen sc1
    s_add_u32 s39, s38, 53248
    buffer_load_dwordx4 v[48:51], v246, s[8:11], s39 offen sc1
    buffer_load_dwordx4 v[52:55], v247, s[8:11], s39 offen sc1
    buffer_load_dwordx4 v[56:59], v248, s[8:11], s39 offen sc1
    buffer_load_dwordx4 v[60:63], v249, s[8:11], s39 offen sc1
    s_add_u32 s39, s38, 8192
    buffer_load_dwordx4 v[84:87], v246, s[8:11], s39 offen sc1
    buffer_load_dwordx4 v[88:91], v247, s[8:11], s39 offen sc1
    buffer_load_dwordx4 v[100:103], v248, s[8:11], s39 offen sc1
    buffer_load_dwordx4 v[104:107], v249, s[8:11], s39 offen sc1
    s_branch sequential_preLN__ssm_conv_s4d__dense_activation_gelu__prompt_kernel_back36
sequential_preLN__ssm_conv_s4d__dense_activation_gelu__prompt_kernel_slow37:
    s_add_u32 s40, s40, 1
    s_cmp_gt_u32 s40, 20000
    s_cbranch_scc1 sequential_preLN__ssm_conv_s4d__dense_activation_gelu__prompt_kernel_back38
    s_add_u32 s39, s38, 36864
    buffer_load_dwordx4 v[28:31], v246, s[8:11], s39 offen sc1
    buffer_load_dwordx4 v[32:35], v247, s[8:11], s39 offen sc1
    buffer_load_dwordx4 v[40:43], v248, s[8:11], s39 offen sc1
    buffer_load_dwordx4 v[44:47], v249, s[8:11], s39 offen sc1
    s_waitcnt vmcnt(0)
    v_bitop3_b32 v78, v31, v35, s50 bitop3:0x7e
    v_bitop3_b32 v81, v43, v47, s50 bitop3:0x7e
    v_or_b32 v78, v78, v81
    v_cmp_le_u32 vcc, 0x10000, v78
    s_cbranch_vccnz sequential_preLN__ssm_conv_s4d__dense_activation_gelu__prompt_kernel_slow37
    s_add_u32 s39, s38, 53248
    buffer_load_dwordx4 v[48:51], v246, s[8:11], s39 offen sc1
    buffer_load_dwordx4 v[52:55], v247, s[8:11], s39 offen sc1
    buffer_load_dwordx4 v[56:59], v248, s[8:11], s39 offen sc1
    buffer_load_dwordx4 v[60:63], v249, s[8:11], s39 offen sc1
    s_add_u32 s39, s38, 8192
    buffer_load_dwordx4 v[84:87], v246, s[8:11], s39 offen sc1
    buffer_load_dwordx4 v[88:91], v247, s[8:11], s39 offen sc1
    buffer_load_dwordx4 v[100:103], v248, s[8:11], s39 offen sc1
    buffer_load_dwordx4 v[104:107], v249, s[8:11], s39 offen sc1
    s_add_u32 s39, s38, 24576
    buffer_load_dwordx4 v[36:39], v246, s[8:11], s39 offen sc1
    buffer_load_dwordx4 v[64:67], v247, s[8:11], s39 offen sc1
    buffer_load_dwordx4 v[68:71], v248, s[8:11], s39 offen sc1
    buffer_load_dwordx4 v[72:75], v249, s[8:11], s39 offen sc1
    s_branch sequential_preLN__ssm_conv_s4d__dense_activation_gelu__prompt_kernel_back38
sequential_preLN__ssm_conv_s4d__dense_activation_gelu__prompt_kernel_slow39:
    s_add_u32 s40, s40, 1
    s_cmp_gt_u32 s40, 20000
    s_cbranch_scc1 sequential_preLN__ssm_conv_s4d__dense_activation_gelu__prompt_kernel_back40
    s_add_u32 s39, s38, 53248
    buffer_load_dwordx4 v[48:51], v246, s[8:11], s39 offen sc1
    buffer_load_dwordx4 v[52:55], v247, s[8:11], s39 offen sc1
    buffer_load_dwordx4 v[56:59], v248, s[8:11], s39 offen sc1
    buffer_load_dwordx4 v[60:63], v249, s[8:11], s39 offen sc1
    s_waitcnt vmcnt(0)
    v_bitop3_b32 v78, v51, v55, s50 bitop3:0x7e
    v_bitop3_b32 v81, v59, v63, s50 bitop3:0x7e
    v_or_b32 v78, v78, v81
    v_cmp_le_u32 vcc, 0x10000, v78
    s_cbranch_vccnz sequential_preLN__ssm_conv_s4d__dense_activation_gelu__prompt_kernel_slow39
    s_add_u32 s39, s38, 8192
    buffer_load_dwordx4 v[84:87], v246, s[8:11], s39 offen sc1
    buffer_load_dwordx4 v[88:91], v247, s[8:11], s39 offen sc1
    buffer_load_dwordx4 v[100:103], v248, s[8:11], s39 offen sc1
    buffer_load_dwordx4 v[104:107], v249, s[8:11], s39 offen sc1
    s_add_u32 s39, s38, 24576
    buffer_load_dwordx4 v[36:39], v246, s[8:11], s39 offen sc1
    buffer_load_dwordx4 v[64:67], v247, s[8:11], s39 offen sc1
    buffer_load_dwordx4 v[68:71], v248, s[8:11], s39 offen sc1
    buffer_load_dwordx4 v[72:75], v249, s[8:11], s39 offen sc1
    s_add_u32 s39, s38, 40960
    buffer_load_dwordx4 v[12:15], v246, s[8:11], s39 offen sc1
    buffer_load_dwordx4 v[16:19], v247, s[8:11], s39 offen sc1
    buffer_load_dwordx4 v[20:23], v248, s[8:11], s39 offen sc1
    buffer_load_dwordx4 v[24:27], v249, s[8:11], s39 offen sc1
    s_branch sequential_preLN__ssm_conv_s4d__dense_activation_gelu__prompt_kernel_back40
sequential_preLN__ssm_conv_s4d__dense_activation_gelu__prompt_kernel_slow41:
    s_add_u32 s40, s40, 1
    s_cmp_gt_u32 s40, 20000
    s_cbranch_scc1 sequential_preLN__ssm_conv_s4d__dense_activation_gelu__prompt_kernel_back42
    s_add_u32 s39, s38, 8192
    buffer_load_dwordx4 v[84:87], v246, s[8:11], s39 offen sc1
    buffer_load_dwordx4 v[88:91], v247, s[8:11], s39 offen sc1
    buffer_load_dwordx4 v[100:103], v248, s[8:11], s39 offen sc1
    buffer_load_dwordx4 v[104:107], v249, s[8:11], s39 offen sc1
    s_waitcnt vmcnt(0)
    v_bitop3_b32 v78, v87, v91, s50 bitop3:0x7e
    v_bitop3_b32 v81, v103, v107, s50 bitop3:0x7e
    v_or_b32 v78, v78, v81
    v_cmp_le_u32 vcc, 0x10000, v78
    s_cbranch_vccnz sequential_preLN__ssm_conv_s4d__dense_activation_gelu__prompt_kernel_slow41
    s_add_u32 s39, s38, 24576
    buffer_load_dwordx4 v[36:39], v246, s[8:11], s39 offen sc1
    buffer_load_dwordx4 v[64:67], v247, s[8:11], s39 offen sc1
    buffer_load_dwordx4 v[68:71], v248, s[8:11], s39 offen sc1
    buffer_load_dwordx4 v[72:75], v249, s[8:11], s39 offen sc1
    s_add_u32 s39, s38, 40960
    buffer_load_dwordx4 v[12:15], v246, s[8:11], s39 offen sc1
    buffer_load_dwordx4 v[16:19], v247, s[8:11], s39 offen sc1
    buffer_load_dwordx4 v[20:23], v248, s[8:11], s39 offen sc1
    buffer_load_dwordx4 v[24:27], v249, s[8:11], s39 offen sc1
    s_add_u32 s39, s38, 57344
    buffer_load_dwordx4 v[28:31], v246, s[8:11], s39 offen sc1
    buffer_load_dwordx4 v[32:35], v247, s[8:11], s39 offen sc1
    buffer_load_dwordx4 v[40:43], v248, s[8:11], s39 offen sc1
    buffer_load_dwordx4 v[44:47], v249, s[8:11], s39 offen sc1
    s_branch sequential_preLN__ssm_conv_s4d__dense_activation_gelu__prompt_kernel_back42
sequential_preLN__ssm_conv_s4d__dense_activation_gelu__prompt_kernel_slow43:
    s_add_u32 s40, s40, 1
    s_cmp_gt_u32 s40, 20000
    s_cbranch_scc1 sequential_preLN__ssm_conv_s4d__dense_activation_gelu__prompt_kernel_back44
    s_add_u32 s39, s38, 24576
    buffer_load_dwordx4 v[36:39], v246, s[8:11], s39 offen sc1
    buffer_load_dwordx4 v[64:67], v247, s[8:11], s39 offen sc1
    buffer_load_dwordx4 v[68:71], v248, s[8:11], s39 offen sc1
    buffer_load_dwordx4 v[72:75], v249, s[8:11], s39 offen sc1
    s_waitcnt vmcnt(0)
    v_bitop3_b32 v78, v39, v67, s50 bitop3:0x7e
    v_bitop3_b32 v81, v71, v75, s50 bitop3:0x7e
    v_or_b32 v78, v78, v81
    v_cmp_le_u32 vcc, 0x10000, v78
    s_cbranch_vccnz sequential_preLN__ssm_conv_s4d__dense_activation_gelu__prompt_kernel_slow43
    s_add_u32 s39, s38, 40960
    buffer_load_dwordx4 v[12:15], v246, s[8:11], s39 offen sc1
    buffer_load_dwordx4 v[16:19], v247, s[8:11], s39 offen sc1
    buffer_load_dwordx4 v[20:23], v248, s[8:11], s39 offen sc1
    buffer_load_dwordx4 v[24:27], v249, s[8:11], s39 offen sc1
    s_add_u32 s39, s38, 57344
    buffer_load_dwordx4 v[28:31], v246, s[8:11], s39 offen sc1
    buffer_load_dwordx4 v[32:35], v247, s[8:11], s39 offen sc1
    buffer_load_dwordx4 v[40:43], v248, s[8:11], s39 offen sc1
    buffer_load_dwordx4 v[44:47], v249, s[8:11], s39 offen sc1
    s_add_u32 s39, s38, 12288
    buffer_load_dwordx4 v[48:51], v246, s[8:11], s39 offen sc1
    buffer_load_dwordx4 v[52:55], v247, s[8:11], s39 offen sc1
    buffer_load_dwordx4 v[56:59], v248, s[8:11], s39 offen sc1
    buffer_load_dwordx4 v[60:63], v249, s[8:11], s39 offen sc1
    s_branch sequential_preLN__ssm_conv_s4d__dense_activation_gelu__prompt_kernel_back44
sequential_preLN__ssm_conv_s4d__dense_activation_gelu__prompt_kernel_slow45:
    s_add_u32 s40, s40, 1
    s_cmp_gt_u32 s40, 20000
    s_cbranch_scc1 sequential_preLN__ssm_conv_s4d__dense_activation_gelu__prompt_kernel_back46
    s_add_u32 s39, s38, 40960
    buffer_load_dwordx4 v[12:15], v246, s[8:11], s39 offen sc1
    buffer_load_dwordx4 v[16:19], v247, s[8:11], s39 offen sc1
    buffer_load_dwordx4 v[20:23], v248, s[8:11], s39 offen sc1
    buffer_load_dwordx4 v[24:27], v249, s[8:11], s39 offen sc1
    s_waitcnt vmcnt(0)
    v_bitop3_b32 v78, v15, v19, s50 bitop3:0x7e
    v_bitop3_b32 v81, v23, v27, s50 bitop3:0x7e
    v_or_b32 v78, v78, v81
    v_cmp_le_u32 vcc, 0x10000, v78
    s_cbranch_vccnz sequential_preLN__ssm_conv_s4d__dense_activation_gelu__prompt_kernel_slow45
    s_add_u32 s39, s38, 57344
    buffer_load_dwordx4 v[28:31], v246, s[8:11], s39 offen sc1
    buffer_load_dwordx4 v[32:35], v247, s[8:11], s39 offen sc1
    buffer_load_dwordx4 v[40:43], v248, s[8:11], s39 offen sc1
    buffer_load_dwordx4 v[44:47], v249, s[8:11], s39 offen sc1
    s_add_u32 s39, s38, 12288
    buffer_load_dwordx4 v[48:51], v246, s[8:11], s39 offen sc1
    buffer_load_dwordx4 v[52:55], v247, s[8:11], s39 offen sc1
    buffer_load_dwordx4 v[56:59], v248, s[8:11], s39 offen sc1
    buffer_load_dwordx4 v[60:63], v249, s[8:11], s39 offen sc1
    s_add_u32 s39, s38, 28672
    buffer_load_dwordx4 v[84:87], v246, s[8:11], s39 offen sc1
    buffer_load_dwordx4 v[88:91], v247, s[8:11], s39 offen sc1
    buffer_load_dwordx4 v[100:103], v248, s[8:11], s39 offen sc1
    buffer_load_dwordx4 v[104:107], v249, s[8:11], s39 offen sc1
    s_branch sequential_preLN__ssm_conv_s4d__dense_activation_gelu__prompt_kernel_back46
sequential_preLN__ssm_conv_s4d__dense_activation_gelu__prompt_kernel_slow47:
    s_add_u32 s40, s40, 1
    s_cmp_gt_u32 s40, 20000
    s_cbranch_scc1 sequential_preLN__ssm_conv_s4d__dense_activation_gelu__prompt_kernel_back48
    s_add_u32 s39, s38, 57344
    buffer_load_dwordx4 v[28:31], v246, s[8:11], s39 offen sc1
    buffer_load_dwordx4 v[32:35], v247, s[8:11], s39 offen sc1
    buffer_load_dwordx4 v[40:43], v248, s[8:11], s39 offen sc1
    buffer_load_dwordx4 v[44:47], v249, s[8:11], s39 offen sc1
    s_waitcnt vmcnt(0)
    v_bitop3_b32 v78, v31, v35, s50 bitop3:0x7e
    v_bitop3_b32 v81, v43, v47, s50 bitop3:0x7e
    v_or_b32 v78, v78, v81
    v_cmp_le_u32 vcc, 0x10000, v78
    s_cbranch_vccnz sequential_preLN__ssm_conv_s4d__dense_activation_gelu__prompt_kernel_slow47
    s_add_u32 s39, s38, 12288
    buffer_load_dwordx4 v[48:51], v246, s[8:11], s39 offen sc1
    buffer_load_dwordx4 v[52:55], v247, s[8:11], s39 offen sc1
    buffer_load_dwordx4 v[56:59], v248, s[8:11], s39 offen sc1
    buffer_load_dwordx4 v[60:63], v249, s[8:11], s39 offen sc1
    s_add_u32 s39, s38, 28672
    buffer_load_dwordx4 v[84:87], v246, s[8:11], s39 offen sc1
    buffer_load_dwordx4 v[88:91], v247, s[8:11], s39 offen sc1
    buffer_load_dwordx4 v[100:103], v248, s[8:11], s39 offen sc1
    buffer_load_dwordx4 v[104:107], v249, s[8:11], s39 offen sc1
    s_add_u32 s39, s38, 45056
    buffer_load_dwordx4 v[36:39], v246, s[8:11], s39 offen sc1
    buffer_load_dwordx4 v[64:67], v247, s[8:11], s39 offen sc1
    buffer_load_dwordx4 v[68:71], v248, s[8:11], s39 offen sc1
    buffer_load_dwordx4 v[72:75], v249, s[8:11], s39 offen sc1
    s_branch sequential_preLN__ssm_conv_s4d__dense_activation_gelu__prompt_kernel_back48
sequential_preLN__ssm_conv_s4d__dense_activation_gelu__prompt_kernel_slow49:
    s_add_u32 s40, s40, 1
    s_cmp_gt_u32 s40, 20000
    s_cbranch_scc1 sequential_preLN__ssm_conv_s4d__dense_activation_gelu__prompt_kernel_back50
    s_add_u32 s39, s38, 12288
    buffer_load_dwordx4 v[48:51], v246, s[8:11], s39 offen sc1
    buffer_load_dwordx4 v[52:55], v247, s[8:11], s39 offen sc1
    buffer_load_dwordx4 v[56:59], v248, s[8:11], s39 offen sc1
    buffer_load_dwordx4 v[60:63], v249, s[8:11], s39 offen sc1
    s_waitcnt vmcnt(0)
    v_bitop3_b32 v78, v51, v55, s50 bitop3:0x7e
    v_bitop3_b32 v81, v59, v63, s50 bitop3:0x7e
    v_or_b32 v78, v78, v81
    v_cmp_le_u32 vcc, 0x10000, v78
    s_cbranch_vccnz sequential_preLN__ssm_conv_s4d__dense_activation_gelu__prompt_kernel_slow49
    s_add_u32 s39, s38, 28672
    buffer_load_dwordx4 v[84:87], v246, s[8:11], s39 offen sc1
    buffer_load_dwordx4 v[88:91], v247, s[8:11], s39 offen sc1
    buffer_load_dwordx4 v[100:103], v248, s[8:11], s39 offen sc1
    buffer_load_dwordx4 v[104:107], v249, s[8:11], s39 offen sc1
    s_add_u32 s39, s38, 45056
    buffer_load_dwordx4 v[36:39], v246, s[8:11], s39 offen sc1
    buffer_load_dwordx4 v[64:67], v247, s[8:11], s39 offen sc1
    buffer_load_dwordx4 v[68:71], v248, s[8:11], s39 offen sc1
    buffer_load_dwordx4 v[72:75], v249, s[8:11], s39 offen sc1
    s_add_u32 s39, s38, 61440
    buffer_load_dwordx4 v[12:15], v246, s[8:11], s39 offen sc1
    buffer_load_dwordx4 v[16:19], v247, s[8:11], s39 offen sc1
    buffer_load_dwordx4 v[20:23], v248, s[8:11], s39 offen sc1
    buffer_load_dwordx4 v[24:27], v249, s[8:11], s39 offen sc1
    s_branch sequential_preLN__ssm_conv_s4d__dense_activation_gelu__prompt_kernel_back50
sequential_preLN__ssm_conv_s4d__dense_activation_gelu__prompt_kernel_slow51:
    s_add_u32 s40, s40, 1
    s_cmp_gt_u32 s40, 20000
    s_cbranch_scc1 sequential_preLN__ssm_conv_s4d__dense_activation_gelu__prompt_kernel_back52
    s_add_u32 s39, s38, 28672
    buffer_load_dwordx4 v[84:87], v246, s[8:11], s39 offen sc1
    buffer_load_dwordx4 v[88:91], v247, s[8:11], s39 offen sc1
    buffer_load_dwordx4 v[100:103], v248, s[8:11], s39 offen sc1
    buffer_load_dwordx4 v[104:107], v249, s[8:11], s39 offen sc1
    s_waitcnt vmcnt(0)
    v_bitop3_b32 v78, v87, v91, s50 bitop3:0x7e
    v_bitop3_b32 v81, v103, v107, s50 bitop3:0x7e
    v_or_b32 v78, v78, v81
    v_cmp_le_u32 vcc, 0x10000, v78
    s_cbranch_vccnz sequential_preLN__ssm_conv_s4d__dense_activation_gelu__prompt_kernel_slow51
    s_add_u32 s39, s38, 45056
    buffer_load_dwordx4 v[36:39], v246, s[8:11], s39 offen sc1
    buffer_load_dwordx4 v[64:67], v247, s[8:11], s39 offen sc1
    buffer_load_dwordx4 v[68:71], v248, s[8:11], s39 offen sc1
    buffer_load_dwordx4 v[72:75], v249, s[8:11], s39 offen sc1
    s_add_u32 s39, s38, 61440
    buffer_load_dwordx4 v[12:15], v246, s[8:11], s39 offen sc1
    buffer_load_dwordx4 v[16:19], v247, s[8:11], s39 offen sc1
    buffer_load_dwordx4 v[20:23], v248, s[8:11], s39 offen sc1
    buffer_load_dwordx4 v[24:27], v249, s[8:11], s39 offen sc1
    s_branch sequential_preLN__ssm_conv_s4d__dense_activation_gelu__prompt_kernel_back52
sequential_preLN__ssm_conv_s4d__dense_activation_gelu__prompt_kernel_slow53:
    s_add_u32 s40, s40, 1
    s_cmp_gt_u32 s40, 20000
    s_cbranch_scc1 sequential_preLN__ssm_conv_s4d__dense_activation_gelu__prompt_kernel_back54
    s_add_u32 s39, s38, 45056
    buffer_load_dwordx4 v[36:39], v246, s[8:11], s39 offen sc1
    buffer_load_dwordx4 v[64:67], v247, s[8:11], s39 offen sc1
    buffer_load_dwordx4 v[68:71], v248, s[8:11], s39 offen sc1
    buffer_load_dwordx4 v[72:75], v249, s[8:11], s39 offen sc1
    s_waitcnt vmcnt(0)
    v_bitop3_b32 v78, v39, v67, s50 bitop3:0x7e
    v_bitop3_b32 v81, v71, v75, s50 bitop3:0x7e
    v_or_b32 v78, v78, v81
    v_cmp_le_u32 vcc, 0x10000, v78
    s_cbranch_vccnz sequential_preLN__ssm_conv_s4d__dense_activation_gelu__prompt_kernel_slow53
    s_add_u32 s39, s38, 61440
    buffer_load_dwordx4 v[12:15], v246, s[8:11], s39 offen sc1
    buffer_load_dwordx4 v[16:19], v247, s[8:11], s39 offen sc1
    buffer_load_dwordx4 v[20:23], v248, s[8:11], s39 offen sc1
    buffer_load_dwordx4 v[24:27], v249, s[8:11], s39 offen sc1
    s_branch sequential_preLN__ssm_conv_s4d__dense_activation_gelu__prompt_kernel_back54
sequential_preLN__ssm_conv_s4d__dense_activation_gelu__prompt_kernel_slow55:
    s_add_u32 s40, s40, 1
    s_cmp_gt_u32 s40, 20000
    s_cbranch_scc1 sequential_preLN__ssm_conv_s4d__dense_activation_gelu__prompt_kernel_back56
    s_add_u32 s39, s38, 61440
    buffer_load_dwordx4 v[12:15], v246, s[8:11], s39 offen sc1
    buffer_load_dwordx4 v[16:19], v247, s[8:11], s39 offen sc1
    buffer_load_dwordx4 v[20:23], v248, s[8:11], s39 offen sc1
    buffer_load_dwordx4 v[24:27], v249, s[8:11], s39 offen sc1
    s_waitcnt vmcnt(0)
    v_bitop3_b32 v78, v15, v19, s50 bitop3:0x7e
    v_bitop3_b32 v81, v23, v27, s50 bitop3:0x7e
    v_or_b32 v78, v78, v81
    v_cmp_le_u32 vcc, 0x10000, v78
    s_cbranch_vccnz sequential_preLN__ssm_conv_s4d__dense_activation_gelu__prompt_kernel_slow55
    s_branch sequential_preLN__ssm_conv_s4d__dense_activation_gelu__prompt_kernel_back56
sequential_preLN__ssm_conv_s4d__dense_activation_gelu__prompt_kernel_codeend:
.p2align 4
.type sequential_preLN__ssm_conv_s4d__dense_activation_gelu__prompt_kernel_gtab,@object
sequential_preLN__ssm_conv_s4d__dense_activation_gelu__prompt_kernel_gtab:
.short 2048,2048,2048,2048,2040,2040,2040,2040,2040,2040,2040,2032,2032,2032,2032,2032
.short 2032,2032,2032,2032,2024,2024,2024,2024,2024,2024,2024,2016,2016,2016,2016,2016
.short 2016,2016,2016,2016,2008,2008,2008,2008,2008,2008,2008,2000,2000,2000,2000,2000
.short 2000,2000,2000,2000,1992,1992,1992,1992,1992,1992,1992,1984,1984,1984,1984,1984
.short 1984,1984,1984,1984,1976,1976,1976,1976,1976,1976,1976,1968,1968,1968,1968,1968
.short 1968,1968,1968,1968,1960,1960,1960,1960,1960,1960,1960,1952,1952,1952,1952,1952
.short 1952,1952,1952,1952,1944,1944,1944,1944,1944,1944,1944,1936,1936,1936,1936,1936
.short 1936,1936,1936,1936,1928,1928,1928,1928,1928,1928,1928,1920,1920,1920,1920,1920
.short 1920,1920,1920,1920,1912,1912,1912,1912,1912,1912,1912,1904,1904,1904,1904,1904
.short 1904,1904,1904,1904,1896,1896,1896,1896,1896,1896,1896,1888,1888,1888,1888,1888
.short 1888,1888,1888,1888,1880,1880,1880,1880,1880,1880,1880,1872,1872,1872,1872,1872
.short 1872,1872,1872,1872,1864,1864,1864,1864,1864,1864,1864,1856,1856,1856,1856,1856
.short 1856,1856,1856,1856,1848,1848,1848,1848,1848,1848,1848,1840,1840,1840,1840,1840
.short 1840,1840,1840,1840,1832,1832,1832,1832,1832,1832,1832,1824,1824,1824,1824,1824
.short 1824,1824,1824,1824,1816,1816,1816,1816,1816,1816,1816,1808,1808,1808,1808,1808
.short 1808,1808,1808,1808,1800,1800,1800,1800,1800,1800,1800,1792,1792,1792,1792,1792
.short 1792,1792,1792,1792,1784,1784,1784,1784,1784,1784,1784,1776,1776,1776,1776,1776
.short 1776,1776,1776,1776,1768,1768,1768,1768,1768,1768,1768,1760,1760,1760,1760,1760
.short 1760,1760,1760,1760,1752,1752,1752,1752,1752,1752,1752,1744,1744,1744,1744,1744
.short 1744,1744,1744,1744,1736,1736,1736,1736,1736,1736,1736,1728,1728,1728,1728,1728
.short 1728,1728,1728,1728,1720,1720,1720,1720,1720,1720,1720,1712,1712,1712,1712,1712
.short 1712,1712,1712,1712,1704,1704,1704,1704,1704,1704,1704,1696,1696,1696,1696,1696
.short 1696,1696,1696,1696,1688,1688,1688,1688,1688,1688,1688,1680,1680,1680,1680,1680
.short 1680,1680,1680,1680,1672,1672,1672,1672,1672,1672,1672,1664,1664,1664,1664,1664
.short 1664,1664,1664,1664,1656,1656,1656,1656,1656,1656,1656,1648,1648,1648,1648,1648
.short 1648,1648,1648,1648,1640,1640,1640,1640,1640,1640,1640,1632,1632,1632,1632,1632
.short 1632,1632,1632,1632,1624,1624,1624,1624,1624,1624,1624,1616,1616,1616,1616,1616
.short 1616,1616,1616,1616,1608,1608,1608,1608,1608,1608,1608,1600,1600,1600,1600,1600
.short 1600,1600,1600,1600,1592,1592,1592,1592,1592,1592,1592,1584,1584,1584,1584,1584
.short 1584,1584,1584,1584,1576,1576,1576,1576,1576,1576,1576,1568,1568,1568,1568,1568
.short 1568,1568,1568,1568,1560,1560,1560,1560,1560,1560,1560,1552,1552,1552,1552,1552
.short 1552,1552,1552,1552,1544,1544,1544,1544,1544,1544,1544,1536,1536,1536,1536,1536
.short 1536,1536,1536,1536,1528,1528,1528,1528,1528,1528,1528,1520,1520,1520,1520,1520
.short 1520,1520,1520,1520,1512,1512,1512,1512,1512,1512,1512,1504,1504,1504,1504,1504
.short 1504,1504,1504,1504,1496,1496,1496,1496,1496,1496,1496,1488,1488,1488,1488,1488
.short 1488,1488,1488,1488,1480,1480,1480,1480,1480,1480,1480,1472,1472,1472,1472,1472
.short 1472,1472,1472,1472,1464,1464,1464,1464,1464,1464,1464,1456,1456,1456,1456,1456
.short 1456,1456,1456,1456,1448,1448,1448,1448,1448,1448,1448,1440,1440,1440,1440,1440
.short 1440,1440,1440,1440,1432,1432,1432,1432,1432,1432,1432,1424,1424,1424,1424,1424
.short 1424,1424,1424,1424,1416,1416,1416,1416,1416,1416,1416,1408,1408,1408,1408,1408
.short 1408,1408,1408,1408,1400,1400,1400,1400,1400,1400,1400,1392,1392,1392,1392,1392
.short 1392,1392,1392,1392,1384,1384,1384,1384,1384,1384,1384,1376,1376,1376,1376,1376
.short 1376,1376,1376,1376,1368,1368,1368,1368,1368,1368,1368,1360,1360,1360,1360,1360
.short 1360,1360,1360,1360,1352,1352,1352,1352,1352,1352,1352,1344,1344,1344,1344,1344
.short 1344,1344,1344,1344,1336,1336,1336,1336,1336,1336,1336,1328,1328,1328,1328,1328
.short 1328,1328,1328,1328,1320,1320,1320,1320,1320,1320,1320,1312,1312,1312,1312,1312
.short 1312,1312,1312,1312,1304,1304,1304,1304,1304,1304,1304,1296,1296,1296,1296,1296
.short 1296,1296,1296,1296,1288,1288,1288,1288,1288,1288,1288,1280,1280,1280,1280,1280
.short 1280,1280,1280,1280,1272,1272,1272,1272,1272,1272,1272,1264,1264,1264,1264,1264
.short 1264,1264,1264,1264,1256,1256,1256,1256,1256,1256,1256,1248,1248,1248,1248,1248
.short 1248,1248,1248,1248,1240,1240,1240,1240,1240,1240,1240,1232,1232,1232,1232,1232
.short 1232,1232,1232,1232,1224,1224,1224,1224,1224,1224,1224,1216,1216,1216,1216,1216
.short 1216,1216,1216,1216,1208,1208,1208,1208,1208,1208,1208,1200,1200,1200,1200,1200
.short 1200,1200,1200,1200,1192,1192,1192,1192,1192,1192,1192,1184,1184,1184,1184,1184
.short 1184,1184,1184,1184,1176,1176,1176,1176,1176,1176,1176,1168,1168,1168,1168,1168
.short 1168,1168,1168,1168,1160,1160,1160,1160,1160,1160,1160,1152,1152,1152,1152,1152
.short 1152,1152,1152,1152,1144,1144,1144,1144,1144,1144,1144,1136,1136,1136,1136,1136
.short 1136,1136,1136,1136,1128,1128,1128,1128,1128,1128,1128,1120,1120,1120,1120,1120
.short 1120,1120,1120,1120,1112,1112,1112,1112,1112,1112,1112,1104,1104,1104,1104,1104
.short 1104,1104,1104,1104,1096,1096,1096,1096,1096,1096,1096,1088,1088,1088,1088,1088
.short 1088,1088,1088,1088,1080,1080,1080,1080,1080,1080,1080,1072,1072,1072,1072,1072
.short 1072,1072,1072,1072,1064,1064,1064,1064,1064,1064,1064,1056,1056,1056,1056,1056
.short 1056,1056,1056,1056,1048,1048,1048,1048,1048,1048,1048,1040,1040,1040,1040,1040
.short 1040,1040,1040,1040,1032,1032,1032,1032,1032,1032,1032,1024,1024,1024,1024,1024
.short 1024,1024,1020,1020,1020,1016,1016,1016,1016,1016,1012,1012,1012,1008,1008,1008
.short 1008,1008,1004,1004,1004,1000,1000,1000,1000,1000,996,996,996,992,992,992
.short 992,992,988,988,988,984,984,984,984,984,980,980,980,976,976,976
.short 976,976,972,972,972,968,968,968,968,968,964,964,964,960,960,960
.short 960,960,956,956,956,952,952,952,952,952,948,948,948,944,944,944
.short 944,944,940,940,940,936,936,936,936,936,932,932,932,928,928,928
.short 928,928,924,924,924,920,920,920,920,920,916,916,916,912,912,912
.short 912,912,908,908,908,904,904,904,904,904,900,900,900,896,896,896
.short 896,896,892,892,892,888,888,888,888,888,884,884,884,880,880,880
.short 880,880,876,876,876,872,872,872,872,872,868,868,868,864,864,864
.short 864,864,860,860,860,856,856,856,856,856,852,852,852,848,848,848
.short 848,848,844,844,844,840,840,840,840,840,836,836,836,832,832,832
.short 832,832,828,828,828,824,824,824,824,824,820,820,820,816,816,816
.short 816,816,812,812,812,808,808,808,808,808,804,804,804,800,800,800
.short 800,800,796,796,796,792,792,792,792,792,788,788,788,784,784,784
.short 784,784,780,780,780,776,776,776,776,776,772,772,772,768,768,768
.short 768,768,764,764,764,760,760,760,760,760,756,756,756,752,752,752
.short 752,752,748,748,748,744,744,744,744,744,740,740,740,736,736,736
.short 736,736,732,732,732,728,728,728,728,728,724,724,724,720,720,720
.short 720,720,716,716,716,712,712,712,712,712,708,708,708,704,704,704
.short 704,704,700,700,700,696,696,696,696,696,692,692,692,688,688,688
.short 688,688,684,684,684,680,680,680,680,680,676,676,676,672,672,672
.short 672,672,668,668,668,664,664,664,664,664,660,660,660,656,656,656
.short 656,656,652,652,652,648,648,648,648,648,644,644,644,640,640,640
.short 640,640,636,636,636,632,632,632,632,632,628,628,628,624,624,624
.short 624,624,620,620,620,616,616,616,616,616,612,612,612,608,608,608
.short 608,608,604,604,604,600,600,600,600,600,596,596,596,592,592,592
.short 592,592,588,588,588,584,584,584,584,584,580,580,580,576,576,576
.short 576,576,572,572,572,568,568,568,568,568,564,564,564,560,560,560
.short 560,560,556,556,556,552,552,552,552,552,548,548,548,544,544,544
.short 544,544,540,540,540,536,536,536,536,536,532,532,532,528,528,528
.short 528,528,524,524,524,520,520,520,520,520,516,516,516,512,512,512
.short 512,510,508,508,508,506,504,504,504,502,500,500,500,498,496,496
.short 496,494,492,492,492,490,488,488,488,486,484,484,484,482,480,480
.short 480,478,476,476,476,474,472,472,472,470,468,468,468,466,464,464
.short 464,462,460,460,460,458,456,456,456,454,452,452,452,450,448,448
.short 448,446,444,444,444,442,440,440,440,438,436,436,436,434,432,432
.short 432,430,428,428,428,426,424,424,424,422,420,420,420,418,416,416
.short 416,414,412,412,412,410,408,408,408,406,404,404,404,402,400,400
.short 400,398,396,396,396,394,392,392,392,390,388,388,388,386,384,384
.short 384,382,380,380,380,378,376,376,376,374,372,372,372,370,368,368
.short 368,366,364,364,364,362,360,360,360,358,356,356,356,354,352,352
.short 352,350,348,348,348,346,344,344,344,342,340,340,340,338,336,336
.short 336,334,332,332,332,330,328,328,328,326,324,324,324,322,320,320
.short 320,318,316,316,316,314,312,312,312,310,308,308,308,306,304,304
.short 304,302,300,300,300,298,296,296,296,294,292,292,292,290,288,288
.short 288,286,284,284,284,282,280,280,280,278,276,276,276,274,272,272
.short 272,270,268,268,268,266,264,264,264,262,260,260,260,258,256,256
.short 2366,254,2364,252,2362,250,2360,248,2358,246,2356,244,2354,242,2352,240
.short 2350,238,2348,236,2346,234,2344,232,2342,230,2340,228,2338,226,2336,224
.short 2334,222,2332,220,2330,218,2328,216,2326,214,2324,212,2322,210,2320,208
.short 2318,206,2316,204,2314,202,2312,200,2310,198,2308,196,2306,194,2304,192
.short 2302,190,2300,188,2298,186,2296,184,2294,182,2292,180,2290,178,2288,176
.short 2286,174,2284,172,2282,170,2280,168,2278,166,2276,164,2274,162,2272,160
.short 2270,158,2268,156,2266,154,2264,152,2262,150,2260,148,2258,146,2256,144
.short 2254,142,2252,140,2250,138,2248,136,2246,134,2244,132,2242,130,2240,128
.short 2238,126,2236,124,2234,122,2232,120,2230,118,2228,116,2226,114,2224,112
.short 2222,110,2220,108,2218,106,2216,104,2214,102,2212,100,2210,98,2208,96
.short 2206,94,2204,92,2202,90,2200,88,2198,86,2196,84,2194,82,2192,80
.short 2190,78,2188,76,2186,74,2184,72,2182,70,2180,68,2178,66,2176,64
.short 2174,62,2172,60,2170,58,2168,56,2166,54,2164,52,2162,50,2160,48
.short 2158,46,2156,44,2154,42,2152,40,2150,38,2148,36,2146,34,2144,32
.short 2142,30,2140,28,2138,26,2136,24,2134,22,2132,20,2130,18,2128,16
.short 2126,14,2124,12,2122,10,2120,8,2118,6,2116,4,2114,2,2112,0
.short 3072,3072,3072,3072,3072,3072,3072,3072,3072,3072,3072,3072,3072,3072,3072,3072
.section .rodata,"a"
.p2align 6
.amdhsa_kernel sequential_preLN__ssm_conv_s4d__dense_activation_gelu__prompt_kernel
  .amdhsa_next_free_vgpr 512
  .amdhsa_next_free_sgpr 73
  .amdhsa_accum_offset 256
  .amdhsa_group_segment_fixed_size 0
  .amdhsa_kernarg_size 120
  .amdhsa_user_sgpr_count 2
  .amdhsa_user_sgpr_kernarg_segment_ptr 1
  .amdhsa_system_sgpr_workgroup_id_x 1
  .amdhsa_float_denorm_mode_32 3
  .amdhsa_float_denorm_mode_16_64 3
  .amdhsa_ieee_mode 0
  .amdhsa_dx10_clamp 0
.end_amdhsa_kernel
```
